```python
import torch

def _softmax(x, axis=-1):
    return torch.softmax(x, dim=axis)
def _gelu(x):
    return torch.nn.functional.gelu(x, approximate="tanh")
def _silu(x):
    return torch.nn.functional.silu(x)
def _sigmoid(x):
    return torch.sigmoid(x)
def _layernorm(x, axis=-1, eps=1e-5):
    m = x.mean(dim=axis, keepdim=True)
    v = x.var(dim=axis, keepdim=True, unbiased=False)
    return (x - m) / torch.sqrt(v + eps)
def _scatter_add(tgt, idx, src, axis=0):
    return tgt.clone().index_add_(axis, idx, src)
def _segment_sum(src, seg, n):
    out = torch.zeros((n,) + src.shape[1:], dtype=src.dtype)
    return out.index_add_(0, seg, src)
def _pad(x, pw):
    flat = tuple(v for pair in reversed(pw) for v in pair)
    return torch.nn.functional.pad(x, flat)

kernel_name = 'recurrent_scan__linear_kernel_hedgehog__mixer_token_mlp__prompt'

def setup_inputs():

    _w = (lambda a: (lambda t: t.to(torch.bfloat16) if t.is_floating_point() else t)(torch.as_tensor(a)))
    def _A_setup():
        B, S, D, H = 1, 2048, 512, 32
        Dh = D // H
        return {
            "x": _w((lambda *s: torch.randn(*s, dtype=torch.bfloat16) * 0.05)(B, S, D)),
            "wqkv": _w((lambda *s: torch.randn(*s, dtype=torch.bfloat16) * 0.4)(D, 3 * D)),
            "w_phi": _w((lambda *s: torch.randn(*s, dtype=torch.bfloat16) * 0.4)(H, Dh, Dh) * (Dh ** -0.5)),
            "wo": _w((lambda *s: torch.randn(*s, dtype=torch.bfloat16) * 0.2)(D, D)),
        }
    _A_in = _A_setup()

    def _B_setup():
        B, S, D, F = 1, 2048, 512, 1376
        return {
            "x": _w((lambda *s: torch.randn(*s, dtype=torch.bfloat16) * 0.05)(B, S, D)),
            "w1": _w((lambda *s: torch.randn(*s, dtype=torch.bfloat16) * 0.4)(S, F) * (S ** -0.5)),
            "b1": _w((lambda *s: torch.randn(*s, dtype=torch.bfloat16) * 3.2)(F) * 0.02),
            "w2": _w((lambda *s: torch.randn(*s, dtype=torch.bfloat16) * 0.4)(F, S) * (F ** -0.5)),
            "b2": _w((lambda *s: torch.randn(*s, dtype=torch.bfloat16) * 0.8)(S) * 0.02),
        }
    _B_in = _B_setup()

    return {
        "A_x": _A_in["x"],
        "A_wqkv": _A_in["wqkv"],
        "A_w_phi": _A_in["w_phi"],
        "A_wo": _A_in["wo"],
        "B_x": _B_in["x"],
        "B_w1": _B_in["w1"],
        "B_b1": _B_in["b1"],
        "B_w2": _B_in["w2"],
        "B_b2": _B_in["b2"],
    }

def reference(A_x, A_wqkv, A_w_phi, A_wo, B_x, B_w1, B_b1, B_w2, B_b2):
    def _A_ref(x, wqkv, w_phi, wo):
        B, S, D = x.shape
        H = 32; Dh = D // H
        qkv = (lambda x, *d: x.permute(*d))((x @ wqkv).reshape(B, S, 3, H, Dh), 2, 0, 3, 1, 4)
        q, k, v = qkv[0], qkv[1], qkv[2]
        pq = torch.einsum("bhsd,hdf->bhsf", q, w_phi)
        pk = torch.einsum("bhsd,hdf->bhsf", k, w_phi)
        phi_q = torch.concatenate([_softmax(pq, axis=-1), _softmax(-pq, axis=-1)], axis=-1)
        phi_k = torch.concatenate([_softmax(pk, axis=-1), _softmax(-pk, axis=-1)], axis=-1)
        kv = torch.einsum("bhsf,bhsd->bhfd", phi_k, v)
        z  = torch.einsum("bhsf->bhf", phi_k)
        num = torch.einsum("bhqf,bhfd->bhqd", phi_q, kv)
        den = torch.einsum("bhqf,bhf->bhq", phi_q, z)[..., None] + 1e-6
        o = num / den
        return (lambda x, *d: x.permute(*d))(o, 0, 2, 1, 3).reshape(B, S, D) @ wo

    def _B_ref(x, w1, b1, w2, b2):
        B, S, D = x.shape
        h = _layernorm(x, axis=-1)
        u = torch.einsum("bsd,sf->bdf", h, w1) + b1
        u = _gelu(u)
        y = torch.einsum("bdf,fs->bds", u, w2) + b2
        return (lambda x, *d: x.permute(*d))(y, 0, 2, 1)

    x = A_x
    xn = _layernorm(x, axis=-1)
    s = _A_ref(xn, A_wqkv, A_w_phi, A_wo)
    g = _silu(_B_ref(xn, B_w1, B_b1, B_w2, B_b2))
    return x + s * g
```

```asm
; @launch grid=(256,1,1) block=(512,1,1) lds=163840
.amdgcn_target "amdgcn-amd-amdhsa--gfx950"
.text
.globl recurrent_scan__linear_kernel_hedgehog__mixer_token_mlp__prompt_kernel
.p2align 8
.type recurrent_scan__linear_kernel_hedgehog__mixer_token_mlp__prompt_kernel,@function
recurrent_scan__linear_kernel_hedgehog__mixer_token_mlp__prompt_kernel:
    s_cmp_ge_u32 s2, 256
    s_cbranch_scc1 L_end
    s_load_dwordx16 s[64:79], s[0:1], 0
    s_load_dwordx8 s[80:87], s[0:1], 64
    s_memrealtime s[92:93]
    v_and_b32 v1, 63, v0
    v_lshrrev_b32 v2, 6, v0
    s_nop 0
    v_readfirstlane_b32 s48, v2
    v_lshlrev_b32 v6, 4, v1
    v_mov_b32 v4, 0
    v_mov_b32 v5, 163808
    ds_write_b32 v5, v4
    s_getpc_b64 s[88:89]
L_pc:
    s_bfe_u32 s54, s2, 0x30003
    s_lshl_b32 s54, s54, 13
    v_lshlrev_b32 v2, 10, v2
    v_lshl_add_u32 v2, v1, 7, v2
    v_add_u32 v2, s54, v2
    v_min_u32 v2, L_end-L_pc, v2
    v_mov_b32 v3, s89
    v_add_co_u32 v2, vcc, s88, v2
    s_nop 1
    v_addc_co_u32 v3, vcc, 0, v3, vcc
    s_mov_b64 exec, 0xff
    global_load_dword v255, v[2:3], off
    s_mov_b64 exec, -1
    s_and_b32 s49, s2, 7
    s_lshr_b32 s50, s2, 3
    s_mov_b32 s6, 2097152
    s_mov_b32 s7, 0x20000
    s_mov_b32 s10, 1572864
    s_mov_b32 s11, 0x20000
    s_mov_b32 s14, 16384
    s_mov_b32 s15, 0x20000
    s_mov_b32 s18, 524288
    s_mov_b32 s19, 0x20000
    s_mov_b32 s22, 5636096
    s_mov_b32 s23, 0x20000
    s_mov_b32 s26, 2752
    s_mov_b32 s27, 0x20000
    s_mov_b32 s30, 5636096
    s_mov_b32 s31, 0x20000
    s_mov_b32 s34, 4096
    s_mov_b32 s35, 0x20000
    s_mov_b32 s38, 2097152
    s_mov_b32 s39, 0x20000
    s_mov_b32 s42, 256
    s_mov_b32 s43, 0x20000
    s_mov_b32 s46, 16777216
    s_mov_b32 s47, 0x20000
    s_lshr_b32 s62, s49, 1
    s_lshl_b32 s62, s62, 5
    s_and_b32 s54, s50, 3
    s_lshl_b32 s54, s54, 3
    s_add_u32 s62, s62, s54
    s_and_b32 s54, s49, 1
    s_lshl_b32 s54, s54, 2
    s_add_u32 s62, s62, s54
    s_bfe_u32 s54, s50, 0x20002
    s_add_u32 s62, s62, s54
    s_lshl_b32 s54, s62, 4
    s_add_u32 s54, s54, s48
    s_lshl_b32 s54, s54, 10
    s_add_u32 s55, s54, 8192
    s_cmp_lt_u32 s50, 16
    s_waitcnt lgkmcnt(0)
    s_mov_b64 s[4:5], s[64:65]
    s_cbranch_scc1 Lx_1
    buffer_load_dwordx4 v[128:131], v6, s[4:7], s54 offen
    buffer_load_dwordx4 v[132:135], v6, s[4:7], s55 offen
Lx_1:
    s_mov_b64 s[40:41], s[84:85]
    s_or_b32 s54, s2, s48
    s_cmp_lg_u32 s54, 0
    s_cbranch_scc1 Lnon_2
    s_xor_b32 s93, s92, 0x5bd1e995
    v_mov_b32 v2, s92
    v_mov_b32 v3, s93
    v_mov_b32 v4, 0
    s_mov_b64 exec, 1
    buffer_store_dwordx2 v[2:3], v4, s[40:43], 0 offen sc1
    s_mov_b64 exec, -1
Lnon_2:
    s_mov_b64 s[8:9], s[66:67]
    s_mov_b64 s[12:13], s[68:69]
    s_mov_b64 s[16:17], s[70:71]
    s_mov_b64 s[20:21], s[74:75]
    s_mov_b64 s[24:25], s[76:77]
    s_mov_b64 s[28:29], s[78:79]
    s_mov_b64 s[32:33], s[80:81]
    s_mov_b64 s[36:37], s[82:83]
    s_mov_b64 s[44:45], s[86:87]
    s_add_u32 s44, s44, 251658240
    s_addc_u32 s45, s45, 0
    s_cmp_lt_u32 s50, 16
    s_cbranch_scc1 L_roleA
    s_lshr_b32 s57, s49, 1
    s_lshl_b32 s57, s57, 2
    s_bfe_u32 s54, s50, 0x20002
    s_add_u32 s57, s57, s54
    s_and_b32 s56, s49, 1
    s_lshl_b32 s56, s56, 2
    s_and_b32 s55, s50, 3
    s_add_u32 s56, s56, s55
    s_add_u32 s51, s54, s55
    s_lshl_b32 s51, s51, 3
    s_and_b32 s54, s56, 4
    s_add_u32 s51, s51, s54
    s_mul_i32 s54, s48, 1088
    s_add_u32 s54, s54, 131072
    v_add_u32 v136, s54, v6
    s_lshl_b32 s54, s48, 3
    s_add_u32 s54, s54, 148480
    v_mov_b32 v139, s54
    v_mov_b32 v140, 0x3727c5ac
    s_and_b32 s67, s48, 3
    s_mul_i32 s54, s67, 44032
    s_mul_i32 s55, s57, 192
    s_add_u32 s54, s54, s55
    v_add_u32 v2, 0, v1
    v_mul_u32_u24 v3, 5462, v2
    v_lshrrev_b32 v3, 16, v3
    v_mul_u32_u24 v5, 12, v3
    v_sub_u32 v5, v2, v5
    v_mul_u32_u24 v3, 2752, v3
    v_lshl_add_u32 v44, v5, 4, v3
    v_add_u32 v44, s54, v44
    v_add_u32 v2, 64, v1
    v_mul_u32_u24 v3, 5462, v2
    v_lshrrev_b32 v3, 16, v3
    v_mul_u32_u24 v5, 12, v3
    v_sub_u32 v5, v2, v5
    v_mul_u32_u24 v3, 2752, v3
    v_lshl_add_u32 v45, v5, 4, v3
    v_add_u32 v45, s54, v45
    v_add_u32 v2, 128, v1
    v_mul_u32_u24 v3, 5462, v2
    v_lshrrev_b32 v3, 16, v3
    v_mul_u32_u24 v5, 12, v3
    v_sub_u32 v5, v2, v5
    v_mul_u32_u24 v3, 2752, v3
    v_lshl_add_u32 v46, v5, 4, v3
    v_add_u32 v46, s54, v46
    s_mul_i32 s64, s67, 3072
    s_cmp_lt_u32 s48, 4
    s_cbranch_scc1 Lew_3
    s_cmp_ge_u32 s57, 15
    s_cbranch_scc1 Lew_3
    s_add_u32 s65, s51, 0
    s_and_b32 s65, s65, 31
    s_mul_i32 s65, s65, 176128
    s_add_u32 m0, s64, 0
    s_nop 0
    buffer_load_dwordx4 v44, s[20:23], s65 offen lds
    s_add_u32 m0, s64, 1024
    s_nop 0
    buffer_load_dwordx4 v45, s[20:23], s65 offen lds
    s_add_u32 m0, s64, 2048
    s_nop 0
    buffer_load_dwordx4 v46, s[20:23], s65 offen lds
    s_waitcnt vmcnt(3)
    s_branch Lew2_4
Lew_3:
    v_mov_b32 v2, 0
    v_mov_b32 v3, 0
    v_mov_b32 v25, 163824
    ds_write_b64 v25, v[2:3]
    ds_write_b64 v25, v[2:3] offset:8
    v_bfe_u32 v137, v1, 2, 2
    v_lshrrev_b32 v138, 5, v1
    v_lshl_add_u32 v137, v138, 3, v137
    v_mul_u32_u24 v137, 1088, v137
    v_bfe_u32 v138, v1, 4, 1
    v_lshl_add_u32 v137, v138, 5, v137
    v_and_b32 v138, 3, v1
    v_lshl_add_u32 v137, v138, 3, v137
    s_and_b32 s55, s48, 3
    s_lshl_b32 s54, s55, 8
    s_add_u32 s54, s54, 131072
    v_add_u32 v137, s54, v137
    s_lshl_b32 s88, s62, 10
    s_lshl_b32 s54, s55, 19
    s_add_u32 s88, s88, s54
    s_add_u32 s88, s88, 2097152
    s_lshl_b32 s86, s62, 7
    s_add_u32 s87, s86, 8650752
    s_add_u32 s86, s86, 8519680
    v_add_u32 v138, 148480, v6
    s_waitcnt vmcnt(0)
Lew2_4:
    v_mov_b32 v4, 0
    buffer_load_dwordx2 v[22:23], v4, s[40:43], 0 offen sc1
    v_lshlrev_b32 v144, 16, v128
    v_and_b32 v145, 0xffff0000, v128
    v_lshlrev_b32 v146, 16, v129
    v_and_b32 v147, 0xffff0000, v129
    v_lshlrev_b32 v148, 16, v130
    v_and_b32 v149, 0xffff0000, v130
    v_lshlrev_b32 v150, 16, v131
    v_and_b32 v151, 0xffff0000, v131
    v_lshlrev_b32 v152, 16, v132
    v_and_b32 v153, 0xffff0000, v132
    v_lshlrev_b32 v154, 16, v133
    v_and_b32 v155, 0xffff0000, v133
    v_lshlrev_b32 v156, 16, v134
    v_and_b32 v157, 0xffff0000, v134
    v_lshlrev_b32 v158, 16, v135
    v_and_b32 v159, 0xffff0000, v135
    v_readfirstlane_b32 s90, v144
    v_readfirstlane_b32 s91, v152
    s_nop 0
    v_mov_b32 v141, s90
    v_mov_b32 v142, s91
    v_sub_f32 v144, v144, v141
    v_sub_f32 v152, v152, v142
    v_sub_f32 v145, v145, v141
    v_sub_f32 v153, v153, v142
    v_sub_f32 v146, v146, v141
    v_sub_f32 v154, v154, v142
    v_sub_f32 v147, v147, v141
    v_sub_f32 v155, v155, v142
    v_sub_f32 v148, v148, v141
    v_sub_f32 v156, v156, v142
    v_sub_f32 v149, v149, v141
    v_sub_f32 v157, v157, v142
    v_sub_f32 v150, v150, v141
    v_sub_f32 v158, v158, v142
    v_sub_f32 v151, v151, v141
    v_sub_f32 v159, v159, v142
    v_add_f32 v160, v144, v145
    v_mul_f32 v161, v144, v144
    v_add_f32 v162, v152, v153
    v_mul_f32 v163, v152, v152
    v_fmac_f32 v161, v145, v145
    v_fmac_f32 v163, v153, v153
    v_add_f32 v160, v160, v146
    v_fmac_f32 v161, v146, v146
    v_add_f32 v162, v162, v154
    v_fmac_f32 v163, v154, v154
    v_add_f32 v160, v160, v147
    v_fmac_f32 v161, v147, v147
    v_add_f32 v162, v162, v155
    v_fmac_f32 v163, v155, v155
    v_add_f32 v160, v160, v148
    v_fmac_f32 v161, v148, v148
    v_add_f32 v162, v162, v156
    v_fmac_f32 v163, v156, v156
    v_add_f32 v160, v160, v149
    v_fmac_f32 v161, v149, v149
    v_add_f32 v162, v162, v157
    v_fmac_f32 v163, v157, v157
    v_add_f32 v160, v160, v150
    v_fmac_f32 v161, v150, v150
    v_add_f32 v162, v162, v158
    v_fmac_f32 v163, v158, v158
    v_add_f32 v160, v160, v151
    v_fmac_f32 v161, v151, v151
    v_add_f32 v162, v162, v159
    v_fmac_f32 v163, v159, v159
    v_permlane16_swap_b32 v160, v161
    s_nop 0
    v_permlane16_swap_b32 v162, v163
    v_add_f32 v160, v160, v161
    v_add_f32 v162, v162, v163
    s_nop 1
    v_permlane32_swap_b32 v160, v162
    v_add_f32 v160, v160, v162
    s_nop 1
    v_add_f32_dpp v160, v160, v160 quad_perm:[1,0,3,2] row_mask:0xf bank_mask:0xf
    s_nop 1
    v_add_f32_dpp v160, v160, v160 quad_perm:[2,3,0,1] row_mask:0xf bank_mask:0xf
    s_nop 1
    v_add_f32_dpp v160, v160, v160 row_half_mirror row_mask:0xf bank_mask:0xf
    s_nop 1
    v_add_f32_dpp v160, v160, v160 row_mirror row_mask:0xf bank_mask:0xf
    v_mul_f32 v160, 0x3b000000, v160
    s_nop 0
    v_readlane_b32 s92, v160, 0
    v_readlane_b32 s93, v160, 16
    v_readlane_b32 s94, v160, 32
    v_readlane_b32 s95, v160, 48
    v_mov_b32 v160, s92
    v_fma_f32 v161, -v160, v160, s93
    v_max_f32 v161, 0, v161
    v_add_f32 v162, v140, v161
    v_fmac_f32 v161, v162, v140
    v_mov_b32 v165, s94
    v_fma_f32 v166, -v165, v165, s95
    v_max_f32 v166, 0, v166
    v_add_f32 v167, v140, v166
    v_fmac_f32 v166, v167, v140
    v_rsq_f32 v161, v161
    v_rsq_f32 v166, v166
    v_rsq_f32 v129, v162
    v_add_f32 v128, v141, v160
    v_mul_f32 v160, v160, v161
    v_rsq_f32 v131, v167
    v_add_f32 v130, v142, v165
    v_mul_f32 v165, v165, v166
    v_fma_f32 v144, v144, v161, -v160
    v_fma_f32 v145, v145, v161, -v160
    v_fma_f32 v146, v146, v161, -v160
    v_fma_f32 v147, v147, v161, -v160
    v_fma_f32 v148, v148, v161, -v160
    v_fma_f32 v149, v149, v161, -v160
    v_fma_f32 v150, v150, v161, -v160
    v_fma_f32 v151, v151, v161, -v160
    v_cvt_pk_bf16_f32 v144, v144, v145
    v_cvt_pk_bf16_f32 v145, v146, v147
    v_cvt_pk_bf16_f32 v146, v148, v149
    v_cvt_pk_bf16_f32 v147, v150, v151
    ds_write_b128 v136, v[144:147] offset:0
    v_fma_f32 v152, v152, v166, -v165
    v_fma_f32 v153, v153, v166, -v165
    v_fma_f32 v154, v154, v166, -v165
    v_fma_f32 v155, v155, v166, -v165
    v_fma_f32 v156, v156, v166, -v165
    v_fma_f32 v157, v157, v166, -v165
    v_fma_f32 v158, v158, v166, -v165
    v_fma_f32 v159, v159, v166, -v165
    v_cvt_pk_bf16_f32 v152, v152, v153
    v_cvt_pk_bf16_f32 v153, v154, v155
    v_cvt_pk_bf16_f32 v154, v156, v157
    v_cvt_pk_bf16_f32 v155, v158, v159
    ds_write_b128 v136, v[152:155] offset:8704
    ds_write_b64 v139, v[128:129] offset:0
    ds_write_b64 v139, v[130:131] offset:64
    s_waitcnt lgkmcnt(0)
    s_barrier
    s_cmp_gt_u32 s48, 3
    s_cbranch_scc1 Lls_5
    ds_read_b64_tr_b16 v[144:145], v137 offset:0
    ds_read_b64_tr_b16 v[146:147], v137 offset:4352
    ds_read_b64_tr_b16 v[148:149], v137 offset:64
    ds_read_b64_tr_b16 v[150:151], v137 offset:4416
    ds_read_b64_tr_b16 v[152:153], v137 offset:128
    ds_read_b64_tr_b16 v[154:155], v137 offset:4480
    ds_read_b64_tr_b16 v[156:157], v137 offset:192
    ds_read_b64_tr_b16 v[158:159], v137 offset:4544
    ds_read_b128 v[160:163], v138
    s_waitcnt lgkmcnt(7)
    buffer_store_dwordx4 v[144:147], v6, s[44:47], s88 offen sc1
    s_add_u32 s88, s88, 0x20000
    s_waitcnt lgkmcnt(5)
    buffer_store_dwordx4 v[148:151], v6, s[44:47], s88 offen sc1
    s_add_u32 s88, s88, 0x20000
    s_waitcnt lgkmcnt(3)
    buffer_store_dwordx4 v[152:155], v6, s[44:47], s88 offen sc1
    s_add_u32 s88, s88, 0x20000
    s_waitcnt lgkmcnt(1)
    buffer_store_dwordx4 v[156:159], v6, s[44:47], s88 offen sc1
    s_cmp_lg_u32 s48, 0
    s_cbranch_scc1 Lst_6
    s_waitcnt lgkmcnt(0)
    s_mov_b64 exec, 0xff
    buffer_store_dwordx4 v[160:163], v6, s[44:47], s87 offen sc1
    s_mov_b64 exec, -1
Lst_6:
Lls_5:
    s_barrier
    s_cmp_ge_u32 s57, 15
    s_cbranch_scc1 L_roleS
    s_cmp_lt_u32 s48, 4
    s_cbranch_scc1 L_bcons
    s_add_u32 s65, s51, 1
    s_and_b32 s65, s65, 31
    s_mul_i32 s65, s65, 176128
    s_add_u32 m0, s64, 12288
    s_nop 0
    buffer_load_dwordx4 v44, s[20:23], s65 offen lds
    s_add_u32 m0, s64, 13312
    s_nop 0
    buffer_load_dwordx4 v45, s[20:23], s65 offen lds
    s_add_u32 m0, s64, 14336
    s_nop 0
    buffer_load_dwordx4 v46, s[20:23], s65 offen lds
    s_add_u32 s65, s51, 2
    s_and_b32 s65, s65, 31
    s_mul_i32 s65, s65, 176128
    s_add_u32 m0, s64, 24576
    s_nop 0
    buffer_load_dwordx4 v44, s[20:23], s65 offen lds
    s_add_u32 m0, s64, 25600
    s_nop 0
    buffer_load_dwordx4 v45, s[20:23], s65 offen lds
    s_add_u32 m0, s64, 26624
    s_nop 0
    buffer_load_dwordx4 v46, s[20:23], s65 offen lds
    s_lshl_b32 s60, s56, 1
    s_lshr_b32 s54, s67, 1
    s_add_u32 s60, s60, s54
    s_lshl_b32 s60, s60, 17
    s_and_b32 s54, s67, 1
    s_lshl_b32 s54, s54, 11
    s_add_u32 s60, s60, s54
    s_add_u32 s60, s60, 2097152
    s_lshl_b32 s63, s67, 11
    s_add_u32 s63, s63, 110592
    s_and_b32 s100, s49, 1
    s_lshl_b32 s100, s100, 2
    s_lshr_b32 s54, s50, 3
    s_add_u32 s100, s100, s54
    s_lshr_b32 s101, s49, 1
    s_lshl_b32 s101, s101, 3
    s_and_b32 s55, s50, 7
    s_add_u32 s101, s101, s55
    s_lshl_b32 s97, s54, 1
    s_add_u32 s97, s97, s55
    s_and_b32 s3, s49, 1
    s_add_u32 s54, s97, s3
    s_and_b32 s54, s54, 7
    s_mul_i32 s3, s54, 11
    s_lshr_b32 s3, s3, 2
    s_waitcnt vmcnt(6)
    s_mov_b32 s96, 0
Lnp_7:
    v_readfirstlane_b32 s52, v22
    v_readfirstlane_b32 s53, v23
    s_nop 0
    s_xor_b32 s95, s52, s53
    s_cmp_eq_u32 s95, 0x5bd1e995
    s_cbranch_scc1 Lnd_8
    s_add_u32 s96, s96, 1
    s_cmp_gt_u32 s96, 20000
    s_cbranch_scc1 Lnd_8
    s_sleep 1
    buffer_load_dwordx2 v[22:23], v4, s[40:43], 0 offen sc1
    s_waitcnt vmcnt(0)
    s_branch Lnp_7
Lnd_8:
    s_add_u32 s65, s51, 3
    s_and_b32 s65, s65, 31
    s_mul_i32 s65, s65, 176128
    s_add_u32 m0, s64, 36864
    s_nop 0
    buffer_load_dwordx4 v44, s[20:23], s65 offen lds
    s_add_u32 m0, s64, 37888
    s_nop 0
    buffer_load_dwordx4 v45, s[20:23], s65 offen lds
    s_add_u32 m0, s64, 38912
    s_nop 0
    buffer_load_dwordx4 v46, s[20:23], s65 offen lds
    s_add_u32 s65, s51, 4
    s_and_b32 s65, s65, 31
    s_mul_i32 s65, s65, 176128
    s_add_u32 m0, s64, 49152
    s_nop 0
    buffer_load_dwordx4 v44, s[20:23], s65 offen lds
    s_add_u32 m0, s64, 50176
    s_nop 0
    buffer_load_dwordx4 v45, s[20:23], s65 offen lds
    s_add_u32 m0, s64, 51200
    s_nop 0
    buffer_load_dwordx4 v46, s[20:23], s65 offen lds
    s_add_u32 s65, s51, 5
    s_and_b32 s65, s65, 31
    s_mul_i32 s65, s65, 176128
    s_add_u32 m0, s64, 61440
    s_nop 0
    buffer_load_dwordx4 v44, s[20:23], s65 offen lds
    s_add_u32 m0, s64, 62464
    s_nop 0
    buffer_load_dwordx4 v45, s[20:23], s65 offen lds
    s_add_u32 m0, s64, 63488
    s_nop 0
    buffer_load_dwordx4 v46, s[20:23], s65 offen lds
    s_add_u32 s65, s51, 6
    s_and_b32 s65, s65, 31
    s_mul_i32 s65, s65, 176128
    s_add_u32 m0, s64, 73728
    s_nop 0
    buffer_load_dwordx4 v44, s[20:23], s65 offen lds
    s_add_u32 m0, s64, 74752
    s_nop 0
    buffer_load_dwordx4 v45, s[20:23], s65 offen lds
    s_add_u32 m0, s64, 75776
    s_nop 0
    buffer_load_dwordx4 v46, s[20:23], s65 offen lds
    s_add_u32 s65, s51, 7
    s_and_b32 s65, s65, 31
    s_mul_i32 s65, s65, 176128
    s_add_u32 m0, s64, 86016
    s_nop 0
    buffer_load_dwordx4 v44, s[20:23], s65 offen lds
    s_add_u32 m0, s64, 87040
    s_nop 0
    buffer_load_dwordx4 v45, s[20:23], s65 offen lds
    s_add_u32 m0, s64, 88064
    s_nop 0
    buffer_load_dwordx4 v46, s[20:23], s65 offen lds
    s_add_u32 s65, s51, 8
    s_and_b32 s65, s65, 31
    s_mul_i32 s65, s65, 176128
    s_add_u32 m0, s64, 98304
    s_nop 0
    buffer_load_dwordx4 v44, s[20:23], s65 offen lds
    s_add_u32 m0, s64, 99328
    s_nop 0
    buffer_load_dwordx4 v45, s[20:23], s65 offen lds
    s_add_u32 m0, s64, 100352
    s_nop 0
    buffer_load_dwordx4 v46, s[20:23], s65 offen lds
    v_lshrrev_b32 v2, 3, v0
    v_and_b32 v3, 7, v0
    v_lshlrev_b32 v56, 10, v2
    v_lshl_add_u32 v56, v3, 4, v56
    s_lshl_b32 s94, s101, 16
    s_lshl_b32 s54, s100, 7
    s_add_u32 s94, s94, s54
    buffer_load_dwordx4 v[36:39], v56, s[4:7], s94 offen
    v_mul_u32_u24 v57, 272, v2
    v_lshl_add_u32 v57, v3, 5, v57
    v_lshlrev_b32 v2, 1, v2
    s_lshl_b32 s54, s101, 7
    buffer_load_ushort v52, v2, s[32:35], s54 offen
    v_mov_b32 v53, 0xbfb8aa3b
    v_bfe_u32 v2, v1, 4, 1
    v_lshlrev_b32 v2, 2, v2
    v_and_b32 v3, 7, v1
    v_xor_b32 v2, v2, v3
    v_lshlrev_b32 v2, 4, v2
    v_lshrrev_b32 v3, 3, v1
    s_and_b32 s68, s48, 3
    s_lshl_b32 s68, s68, 1
    s_lshl_b32 s69, s68, 10
    v_lshl_add_u32 v60, v3, 12, v2
    s_lshl_b32 s54, s68, 15
    s_lshl_b32 s55, s101, 7
    s_add_u32 s54, s54, s55
    v_add_u32 v60, s54, v60
    v_lshl_add_u32 v62, v3, 10, v2
    s_lshl_b32 s54, s68, 13
    s_lshl_b32 s55, s100, 7
    s_add_u32 s54, s54, s55
    v_add_u32 v62, s54, v62
    v_add_u32 v61, 0x8000, v60
    v_add_u32 v63, 0x2000, v62
    v_and_b32 v3, 7, v1
    s_lshr_b32 s54, s101, 1
    s_lshl_b32 s54, s54, 3
    v_add_u32 v3, s54, v3
    v_lshlrev_b32 v3, 7, v3
    v_add_u32 v59, 8568832, v3
    v_min_u32 v2, 14, v1
    s_mul_i32 s54, s100, 15
    v_add_u32 v2, s54, v2
    v_lshlrev_b32 v2, 7, v2
    v_add_u32 v58, 8585216, v2
    s_bfe_u32 s55, s48, 0x10001
    s_and_b32 s68, s48, 1
    s_lshl_b32 s68, s68, 11
    s_lshl_b32 s93, s100, 1
    s_add_u32 s93, s93, s55
    s_mul_i32 s93, s93, 92160
    s_add_u32 s93, s93, s68
    s_add_u32 s93, s93, 6291456
    s_and_b32 s68, s48, 1
    s_lshl_b32 s92, s101, 1
    s_add_u32 s92, s92, s68
    s_lshl_b32 s92, s92, 15
    s_lshl_b32 s54, s55, 11
    s_add_u32 s92, s92, s54
    s_add_u32 s92, s92, 4194304
    v_bfe_u32 v2, v1, 2, 2
    v_lshrrev_b32 v3, 5, v1
    v_lshl_add_u32 v28, v3, 2, v2
    v_lshlrev_b32 v28, 7, v28
    v_lshrrev_b32 v2, 1, v2
    v_lshl_add_u32 v28, v2, 6, v28
    v_bfe_u32 v2, v1, 4, 1
    v_lshl_add_u32 v28, v2, 5, v28
    v_and_b32 v2, 3, v1
    v_lshl_add_u32 v28, v2, 3, v28
    s_lshl_b32 s54, s55, 12
    v_add_u32 v28, s54, v28
    v_xor_b32 v29, 64, v28
    v_add_u32 v30, 0x10000, v28
    v_add_u32 v31, 0x10000, v29
    v_and_b32 v2, 31, v1
    v_mul_u32_u24 v2, 272, v2
    v_lshl_add_u32 v54, v3, 4, v2
    s_mul_i32 s54, s55, 17408
    v_add_u32 v54, s54, v54
    s_mul_i32 s54, s68, 8704
    v_add_u32 v54, s54, v54
    s_lshl_b32 s70, s3, 12
    s_add_u32 s70, s70, s93
    s_add_u32 s68, s93, 90112
    s_add_u32 s71, s70, 4096
    s_cmp_ge_u32 s71, s68
    s_cselect_b32 s71, s93, s71
    s_add_u32 s72, s71, 4096
    s_cmp_ge_u32 s72, s68
    s_cselect_b32 s72, s93, s72
    s_add_u32 s73, s72, 4096
    s_cmp_ge_u32 s73, s68
    s_cselect_b32 s73, s93, s73
    s_add_u32 s74, s73, 4096
    s_cmp_ge_u32 s74, s68
    s_cselect_b32 s74, s93, s74
    s_add_u32 s75, s74, 4096
    s_cmp_ge_u32 s75, s68
    s_cselect_b32 s75, s93, s75
    s_add_u32 s76, s75, 4096
    s_cmp_ge_u32 s76, s68
    s_cselect_b32 s76, s93, s76
    s_add_u32 s77, s76, 4096
    s_cmp_ge_u32 s77, s68
    s_cselect_b32 s77, s93, s77
    s_add_u32 s78, s77, 4096
    s_cmp_ge_u32 s78, s68
    s_cselect_b32 s78, s93, s78
    s_add_u32 s79, s78, 4096
    s_cmp_ge_u32 s79, s68
    s_cselect_b32 s79, s93, s79
    s_add_u32 s80, s79, 4096
    s_cmp_ge_u32 s80, s68
    s_cselect_b32 s80, s93, s80
    s_add_u32 s81, s80, 4096
    s_cmp_ge_u32 s81, s68
    s_cselect_b32 s81, s93, s81
    s_add_u32 s82, s81, 4096
    s_cmp_ge_u32 s82, s68
    s_cselect_b32 s82, s93, s82
    s_add_u32 s83, s82, 4096
    s_cmp_ge_u32 s83, s68
    s_cselect_b32 s83, s93, s83
    s_add_u32 s84, s83, 4096
    s_cmp_ge_u32 s84, s68
    s_cselect_b32 s84, s93, s84
    s_add_u32 s85, s84, 4096
    s_cmp_ge_u32 s85, s68
    s_cselect_b32 s85, s93, s85
    s_add_u32 s86, s85, 4096
    s_cmp_ge_u32 s86, s68
    s_cselect_b32 s86, s93, s86
    s_add_u32 s87, s86, 4096
    s_cmp_ge_u32 s87, s68
    s_cselect_b32 s87, s93, s87
    s_add_u32 s88, s87, 4096
    s_cmp_ge_u32 s88, s68
    s_cselect_b32 s88, s93, s88
    s_add_u32 s89, s88, 4096
    s_cmp_ge_u32 s89, s68
    s_cselect_b32 s89, s93, s89
    s_add_u32 s90, s89, 4096
    s_cmp_ge_u32 s90, s68
    s_cselect_b32 s90, s93, s90
    s_add_u32 s91, s90, 4096
    s_cmp_ge_u32 s91, s68
    s_cselect_b32 s91, s93, s91
    s_barrier
    s_add_u32 s65, s51, 0
    s_and_b32 s65, s65, 31
    s_lshl_b32 s65, s65, 12
    s_add_u32 s65, s65, s60
    s_add_u32 m0, s63, 0
    s_nop 0
    buffer_load_dwordx4 v6, s[44:47], s65 offen sc1 lds
    buffer_load_dwordx4 v6, s[44:47], s65 offen offset:1024 sc1 lds
    s_add_u32 s65, s51, 1
    s_and_b32 s65, s65, 31
    s_lshl_b32 s65, s65, 12
    s_add_u32 s65, s65, s60
    s_add_u32 m0, s63, 8192
    s_nop 0
    buffer_load_dwordx4 v6, s[44:47], s65 offen sc1 lds
    buffer_load_dwordx4 v6, s[44:47], s65 offen offset:1024 sc1 lds
    s_add_u32 s65, s51, 2
    s_and_b32 s65, s65, 31
    s_lshl_b32 s65, s65, 12
    s_add_u32 s65, s65, s60
    s_add_u32 m0, s63, 16384
    s_nop 0
    buffer_load_dwordx4 v6, s[44:47], s65 offen sc1 lds
    buffer_load_dwordx4 v6, s[44:47], s65 offen offset:1024 sc1 lds
    s_add_u32 s65, s51, 3
    s_and_b32 s65, s65, 31
    s_lshl_b32 s65, s65, 12
    s_add_u32 s65, s65, s60
    s_add_u32 m0, s63, 24576
    s_nop 0
    buffer_load_dwordx4 v6, s[44:47], s65 offen sc1 lds
    buffer_load_dwordx4 v6, s[44:47], s65 offen offset:1024 sc1 lds
    s_add_u32 s65, s51, 4
    s_and_b32 s65, s65, 31
    s_lshl_b32 s65, s65, 12
    s_add_u32 s65, s65, s60
    s_add_u32 m0, s63, 32768
    s_nop 0
    buffer_load_dwordx4 v6, s[44:47], s65 offen sc1 lds
    buffer_load_dwordx4 v6, s[44:47], s65 offen offset:1024 sc1 lds
    s_waitcnt vmcnt(6)
    s_barrier
    s_add_u32 s65, s51, 5
    s_and_b32 s65, s65, 31
    s_lshl_b32 s65, s65, 12
    s_add_u32 s65, s65, s60
    s_add_u32 m0, s63, 40960
    s_nop 0
    buffer_load_dwordx4 v6, s[44:47], s65 offen sc1 lds
    buffer_load_dwordx4 v6, s[44:47], s65 offen offset:1024 sc1 lds
    s_waitcnt vmcnt(6)
    s_barrier
    s_add_u32 s65, s51, 6
    s_and_b32 s65, s65, 31
    s_lshl_b32 s65, s65, 12
    s_add_u32 s65, s65, s60
    s_add_u32 m0, s63, 0
    s_nop 0
    buffer_load_dwordx4 v6, s[44:47], s65 offen sc1 lds
    buffer_load_dwordx4 v6, s[44:47], s65 offen offset:1024 sc1 lds
    s_add_u32 s65, s51, 9
    s_and_b32 s65, s65, 31
    s_mul_i32 s65, s65, 176128
    s_add_u32 m0, s64, 0
    s_nop 0
    buffer_load_dwordx4 v44, s[20:23], s65 offen lds
    s_add_u32 m0, s64, 1024
    s_nop 0
    buffer_load_dwordx4 v45, s[20:23], s65 offen lds
    s_add_u32 m0, s64, 2048
    s_nop 0
    buffer_load_dwordx4 v46, s[20:23], s65 offen lds
    s_waitcnt vmcnt(9)
    s_barrier
    s_add_u32 s65, s51, 7
    s_and_b32 s65, s65, 31
    s_lshl_b32 s65, s65, 12
    s_add_u32 s65, s65, s60
    s_add_u32 m0, s63, 8192
    s_nop 0
    buffer_load_dwordx4 v6, s[44:47], s65 offen sc1 lds
    buffer_load_dwordx4 v6, s[44:47], s65 offen offset:1024 sc1 lds
    s_add_u32 s65, s51, 10
    s_and_b32 s65, s65, 31
    s_mul_i32 s65, s65, 176128
    s_add_u32 m0, s64, 12288
    s_nop 0
    buffer_load_dwordx4 v44, s[20:23], s65 offen lds
    s_add_u32 m0, s64, 13312
    s_nop 0
    buffer_load_dwordx4 v45, s[20:23], s65 offen lds
    s_add_u32 m0, s64, 14336
    s_nop 0
    buffer_load_dwordx4 v46, s[20:23], s65 offen lds
    s_waitcnt vmcnt(12)
    s_barrier
    s_add_u32 s65, s51, 8
    s_and_b32 s65, s65, 31
    s_lshl_b32 s65, s65, 12
    s_add_u32 s65, s65, s60
    s_add_u32 m0, s63, 16384
    s_nop 0
    buffer_load_dwordx4 v6, s[44:47], s65 offen sc1 lds
    buffer_load_dwordx4 v6, s[44:47], s65 offen offset:1024 sc1 lds
    s_add_u32 s65, s51, 11
    s_and_b32 s65, s65, 31
    s_mul_i32 s65, s65, 176128
    s_add_u32 m0, s64, 24576
    s_nop 0
    buffer_load_dwordx4 v44, s[20:23], s65 offen lds
    s_add_u32 m0, s64, 25600
    s_nop 0
    buffer_load_dwordx4 v45, s[20:23], s65 offen lds
    s_add_u32 m0, s64, 26624
    s_nop 0
    buffer_load_dwordx4 v46, s[20:23], s65 offen lds
    s_waitcnt vmcnt(15)
    s_barrier
    s_add_u32 s65, s51, 9
    s_and_b32 s65, s65, 31
    s_lshl_b32 s65, s65, 12
    s_add_u32 s65, s65, s60
    s_add_u32 m0, s63, 24576
    s_nop 0
    buffer_load_dwordx4 v6, s[44:47], s65 offen sc1 lds
    buffer_load_dwordx4 v6, s[44:47], s65 offen offset:1024 sc1 lds
    s_add_u32 s65, s51, 12
    s_and_b32 s65, s65, 31
    s_mul_i32 s65, s65, 176128
    s_add_u32 m0, s64, 36864
    s_nop 0
    buffer_load_dwordx4 v44, s[20:23], s65 offen lds
    s_add_u32 m0, s64, 37888
    s_nop 0
    buffer_load_dwordx4 v45, s[20:23], s65 offen lds
    s_add_u32 m0, s64, 38912
    s_nop 0
    buffer_load_dwordx4 v46, s[20:23], s65 offen lds
    s_waitcnt vmcnt(18)
    s_barrier
    s_add_u32 s65, s51, 10
    s_and_b32 s65, s65, 31
    s_lshl_b32 s65, s65, 12
    s_add_u32 s65, s65, s60
    s_add_u32 m0, s63, 32768
    s_nop 0
    buffer_load_dwordx4 v6, s[44:47], s65 offen sc1 lds
    buffer_load_dwordx4 v6, s[44:47], s65 offen offset:1024 sc1 lds
    s_add_u32 s65, s51, 13
    s_and_b32 s65, s65, 31
    s_mul_i32 s65, s65, 176128
    s_add_u32 m0, s64, 49152
    s_nop 0
    buffer_load_dwordx4 v44, s[20:23], s65 offen lds
    s_add_u32 m0, s64, 50176
    s_nop 0
    buffer_load_dwordx4 v45, s[20:23], s65 offen lds
    s_add_u32 m0, s64, 51200
    s_nop 0
    buffer_load_dwordx4 v46, s[20:23], s65 offen lds
    s_waitcnt vmcnt(18)
    s_barrier
    s_add_u32 s65, s51, 11
    s_and_b32 s65, s65, 31
    s_lshl_b32 s65, s65, 12
    s_add_u32 s65, s65, s60
    s_add_u32 m0, s63, 40960
    s_nop 0
    buffer_load_dwordx4 v6, s[44:47], s65 offen sc1 lds
    buffer_load_dwordx4 v6, s[44:47], s65 offen offset:1024 sc1 lds
    s_add_u32 s65, s51, 14
    s_and_b32 s65, s65, 31
    s_mul_i32 s65, s65, 176128
    s_add_u32 m0, s64, 61440
    s_nop 0
    buffer_load_dwordx4 v44, s[20:23], s65 offen lds
    s_add_u32 m0, s64, 62464
    s_nop 0
    buffer_load_dwordx4 v45, s[20:23], s65 offen lds
    s_add_u32 m0, s64, 63488
    s_nop 0
    buffer_load_dwordx4 v46, s[20:23], s65 offen lds
    s_waitcnt vmcnt(18)
    s_barrier
    s_add_u32 s65, s51, 12
    s_and_b32 s65, s65, 31
    s_lshl_b32 s65, s65, 12
    s_add_u32 s65, s65, s60
    s_add_u32 m0, s63, 0
    s_nop 0
    buffer_load_dwordx4 v6, s[44:47], s65 offen sc1 lds
    buffer_load_dwordx4 v6, s[44:47], s65 offen offset:1024 sc1 lds
    s_add_u32 s65, s51, 15
    s_and_b32 s65, s65, 31
    s_mul_i32 s65, s65, 176128
    s_add_u32 m0, s64, 73728
    s_nop 0
    buffer_load_dwordx4 v44, s[20:23], s65 offen lds
    s_add_u32 m0, s64, 74752
    s_nop 0
    buffer_load_dwordx4 v45, s[20:23], s65 offen lds
    s_add_u32 m0, s64, 75776
    s_nop 0
    buffer_load_dwordx4 v46, s[20:23], s65 offen lds
    s_waitcnt vmcnt(18)
    s_barrier
    s_add_u32 s65, s51, 13
    s_and_b32 s65, s65, 31
    s_lshl_b32 s65, s65, 12
    s_add_u32 s65, s65, s60
    s_add_u32 m0, s63, 8192
    s_nop 0
    buffer_load_dwordx4 v6, s[44:47], s65 offen sc1 lds
    buffer_load_dwordx4 v6, s[44:47], s65 offen offset:1024 sc1 lds
    s_add_u32 s65, s51, 16
    s_and_b32 s65, s65, 31
    s_mul_i32 s65, s65, 176128
    s_add_u32 m0, s64, 86016
    s_nop 0
    buffer_load_dwordx4 v44, s[20:23], s65 offen lds
    s_add_u32 m0, s64, 87040
    s_nop 0
    buffer_load_dwordx4 v45, s[20:23], s65 offen lds
    s_add_u32 m0, s64, 88064
    s_nop 0
    buffer_load_dwordx4 v46, s[20:23], s65 offen lds
    s_waitcnt vmcnt(18)
    s_barrier
    s_add_u32 s65, s51, 14
    s_and_b32 s65, s65, 31
    s_lshl_b32 s65, s65, 12
    s_add_u32 s65, s65, s60
    s_add_u32 m0, s63, 16384
    s_nop 0
    buffer_load_dwordx4 v6, s[44:47], s65 offen sc1 lds
    buffer_load_dwordx4 v6, s[44:47], s65 offen offset:1024 sc1 lds
    s_add_u32 s65, s51, 17
    s_and_b32 s65, s65, 31
    s_mul_i32 s65, s65, 176128
    s_add_u32 m0, s64, 98304
    s_nop 0
    buffer_load_dwordx4 v44, s[20:23], s65 offen lds
    s_add_u32 m0, s64, 99328
    s_nop 0
    buffer_load_dwordx4 v45, s[20:23], s65 offen lds
    s_add_u32 m0, s64, 100352
    s_nop 0
    buffer_load_dwordx4 v46, s[20:23], s65 offen lds
    s_waitcnt vmcnt(18)
    s_barrier
    s_add_u32 s65, s51, 15
    s_and_b32 s65, s65, 31
    s_lshl_b32 s65, s65, 12
    s_add_u32 s65, s65, s60
    s_add_u32 m0, s63, 24576
    s_nop 0
    buffer_load_dwordx4 v6, s[44:47], s65 offen sc1 lds
    buffer_load_dwordx4 v6, s[44:47], s65 offen offset:1024 sc1 lds
    s_add_u32 s65, s51, 18
    s_and_b32 s65, s65, 31
    s_mul_i32 s65, s65, 176128
    s_add_u32 m0, s64, 0
    s_nop 0
    buffer_load_dwordx4 v44, s[20:23], s65 offen lds
    s_add_u32 m0, s64, 1024
    s_nop 0
    buffer_load_dwordx4 v45, s[20:23], s65 offen lds
    s_add_u32 m0, s64, 2048
    s_nop 0
    buffer_load_dwordx4 v46, s[20:23], s65 offen lds
    s_waitcnt vmcnt(18)
    s_barrier
    s_add_u32 s65, s51, 16
    s_and_b32 s65, s65, 31
    s_lshl_b32 s65, s65, 12
    s_add_u32 s65, s65, s60
    s_add_u32 m0, s63, 32768
    s_nop 0
    buffer_load_dwordx4 v6, s[44:47], s65 offen sc1 lds
    buffer_load_dwordx4 v6, s[44:47], s65 offen offset:1024 sc1 lds
    s_add_u32 s65, s51, 19
    s_and_b32 s65, s65, 31
    s_mul_i32 s65, s65, 176128
    s_add_u32 m0, s64, 12288
    s_nop 0
    buffer_load_dwordx4 v44, s[20:23], s65 offen lds
    s_add_u32 m0, s64, 13312
    s_nop 0
    buffer_load_dwordx4 v45, s[20:23], s65 offen lds
    s_add_u32 m0, s64, 14336
    s_nop 0
    buffer_load_dwordx4 v46, s[20:23], s65 offen lds
    s_waitcnt vmcnt(18)
    s_barrier
    s_add_u32 s65, s51, 17
    s_and_b32 s65, s65, 31
    s_lshl_b32 s65, s65, 12
    s_add_u32 s65, s65, s60
    s_add_u32 m0, s63, 40960
    s_nop 0
    buffer_load_dwordx4 v6, s[44:47], s65 offen sc1 lds
    buffer_load_dwordx4 v6, s[44:47], s65 offen offset:1024 sc1 lds
    s_add_u32 s65, s51, 20
    s_and_b32 s65, s65, 31
    s_mul_i32 s65, s65, 176128
    s_add_u32 m0, s64, 24576
    s_nop 0
    buffer_load_dwordx4 v44, s[20:23], s65 offen lds
    s_add_u32 m0, s64, 25600
    s_nop 0
    buffer_load_dwordx4 v45, s[20:23], s65 offen lds
    s_add_u32 m0, s64, 26624
    s_nop 0
    buffer_load_dwordx4 v46, s[20:23], s65 offen lds
    s_waitcnt vmcnt(18)
    s_barrier
    s_add_u32 s65, s51, 18
    s_and_b32 s65, s65, 31
    s_lshl_b32 s65, s65, 12
    s_add_u32 s65, s65, s60
    s_add_u32 m0, s63, 0
    s_nop 0
    buffer_load_dwordx4 v6, s[44:47], s65 offen sc1 lds
    buffer_load_dwordx4 v6, s[44:47], s65 offen offset:1024 sc1 lds
    s_add_u32 s65, s51, 21
    s_and_b32 s65, s65, 31
    s_mul_i32 s65, s65, 176128
    s_add_u32 m0, s64, 36864
    s_nop 0
    buffer_load_dwordx4 v44, s[20:23], s65 offen lds
    s_add_u32 m0, s64, 37888
    s_nop 0
    buffer_load_dwordx4 v45, s[20:23], s65 offen lds
    s_add_u32 m0, s64, 38912
    s_nop 0
    buffer_load_dwordx4 v46, s[20:23], s65 offen lds
    s_waitcnt vmcnt(18)
    s_barrier
    s_add_u32 s65, s51, 19
    s_and_b32 s65, s65, 31
    s_lshl_b32 s65, s65, 12
    s_add_u32 s65, s65, s60
    s_add_u32 m0, s63, 8192
    s_nop 0
    buffer_load_dwordx4 v6, s[44:47], s65 offen sc1 lds
    buffer_load_dwordx4 v6, s[44:47], s65 offen offset:1024 sc1 lds
    s_add_u32 s65, s51, 22
    s_and_b32 s65, s65, 31
    s_mul_i32 s65, s65, 176128
    s_add_u32 m0, s64, 49152
    s_nop 0
    buffer_load_dwordx4 v44, s[20:23], s65 offen lds
    s_add_u32 m0, s64, 50176
    s_nop 0
    buffer_load_dwordx4 v45, s[20:23], s65 offen lds
    s_add_u32 m0, s64, 51200
    s_nop 0
    buffer_load_dwordx4 v46, s[20:23], s65 offen lds
    s_waitcnt vmcnt(18)
    s_barrier
    s_add_u32 s65, s51, 20
    s_and_b32 s65, s65, 31
    s_lshl_b32 s65, s65, 12
    s_add_u32 s65, s65, s60
    s_add_u32 m0, s63, 16384
    s_nop 0
    buffer_load_dwordx4 v6, s[44:47], s65 offen sc1 lds
    buffer_load_dwordx4 v6, s[44:47], s65 offen offset:1024 sc1 lds
    s_add_u32 s65, s51, 23
    s_and_b32 s65, s65, 31
    s_mul_i32 s65, s65, 176128
    s_add_u32 m0, s64, 61440
    s_nop 0
    buffer_load_dwordx4 v44, s[20:23], s65 offen lds
    s_add_u32 m0, s64, 62464
    s_nop 0
    buffer_load_dwordx4 v45, s[20:23], s65 offen lds
    s_add_u32 m0, s64, 63488
    s_nop 0
    buffer_load_dwordx4 v46, s[20:23], s65 offen lds
    s_waitcnt vmcnt(18)
    s_barrier
    s_add_u32 s65, s51, 21
    s_and_b32 s65, s65, 31
    s_lshl_b32 s65, s65, 12
    s_add_u32 s65, s65, s60
    s_add_u32 m0, s63, 24576
    s_nop 0
    buffer_load_dwordx4 v6, s[44:47], s65 offen sc1 lds
    buffer_load_dwordx4 v6, s[44:47], s65 offen offset:1024 sc1 lds
    s_add_u32 s65, s51, 24
    s_and_b32 s65, s65, 31
    s_mul_i32 s65, s65, 176128
    s_add_u32 m0, s64, 73728
    s_nop 0
    buffer_load_dwordx4 v44, s[20:23], s65 offen lds
    s_add_u32 m0, s64, 74752
    s_nop 0
    buffer_load_dwordx4 v45, s[20:23], s65 offen lds
    s_add_u32 m0, s64, 75776
    s_nop 0
    buffer_load_dwordx4 v46, s[20:23], s65 offen lds
    s_waitcnt vmcnt(18)
    s_barrier
    s_add_u32 s65, s51, 22
    s_and_b32 s65, s65, 31
    s_lshl_b32 s65, s65, 12
    s_add_u32 s65, s65, s60
    s_add_u32 m0, s63, 32768
    s_nop 0
    buffer_load_dwordx4 v6, s[44:47], s65 offen sc1 lds
    buffer_load_dwordx4 v6, s[44:47], s65 offen offset:1024 sc1 lds
    s_add_u32 s65, s51, 25
    s_and_b32 s65, s65, 31
    s_mul_i32 s65, s65, 176128
    s_add_u32 m0, s64, 86016
    s_nop 0
    buffer_load_dwordx4 v44, s[20:23], s65 offen lds
    s_add_u32 m0, s64, 87040
    s_nop 0
    buffer_load_dwordx4 v45, s[20:23], s65 offen lds
    s_add_u32 m0, s64, 88064
    s_nop 0
    buffer_load_dwordx4 v46, s[20:23], s65 offen lds
    s_waitcnt vmcnt(18)
    s_barrier
    s_add_u32 s65, s51, 23
    s_and_b32 s65, s65, 31
    s_lshl_b32 s65, s65, 12
    s_add_u32 s65, s65, s60
    s_add_u32 m0, s63, 40960
    s_nop 0
    buffer_load_dwordx4 v6, s[44:47], s65 offen sc1 lds
    buffer_load_dwordx4 v6, s[44:47], s65 offen offset:1024 sc1 lds
    s_add_u32 s65, s51, 26
    s_and_b32 s65, s65, 31
    s_mul_i32 s65, s65, 176128
    s_add_u32 m0, s64, 98304
    s_nop 0
    buffer_load_dwordx4 v44, s[20:23], s65 offen lds
    s_add_u32 m0, s64, 99328
    s_nop 0
    buffer_load_dwordx4 v45, s[20:23], s65 offen lds
    s_add_u32 m0, s64, 100352
    s_nop 0
    buffer_load_dwordx4 v46, s[20:23], s65 offen lds
    s_waitcnt vmcnt(18)
    s_barrier
    s_add_u32 s65, s51, 24
    s_and_b32 s65, s65, 31
    s_lshl_b32 s65, s65, 12
    s_add_u32 s65, s65, s60
    s_add_u32 m0, s63, 0
    s_nop 0
    buffer_load_dwordx4 v6, s[44:47], s65 offen sc1 lds
    buffer_load_dwordx4 v6, s[44:47], s65 offen offset:1024 sc1 lds
    s_add_u32 s65, s51, 27
    s_and_b32 s65, s65, 31
    s_mul_i32 s65, s65, 176128
    s_add_u32 m0, s64, 0
    s_nop 0
    buffer_load_dwordx4 v44, s[20:23], s65 offen lds
    s_add_u32 m0, s64, 1024
    s_nop 0
    buffer_load_dwordx4 v45, s[20:23], s65 offen lds
    s_add_u32 m0, s64, 2048
    s_nop 0
    buffer_load_dwordx4 v46, s[20:23], s65 offen lds
    s_waitcnt vmcnt(18)
    s_barrier
    s_add_u32 s65, s51, 25
    s_and_b32 s65, s65, 31
    s_lshl_b32 s65, s65, 12
    s_add_u32 s65, s65, s60
    s_add_u32 m0, s63, 8192
    s_nop 0
    buffer_load_dwordx4 v6, s[44:47], s65 offen sc1 lds
    buffer_load_dwordx4 v6, s[44:47], s65 offen offset:1024 sc1 lds
    s_add_u32 s65, s51, 28
    s_and_b32 s65, s65, 31
    s_mul_i32 s65, s65, 176128
    s_add_u32 m0, s64, 12288
    s_nop 0
    buffer_load_dwordx4 v44, s[20:23], s65 offen lds
    s_add_u32 m0, s64, 13312
    s_nop 0
    buffer_load_dwordx4 v45, s[20:23], s65 offen lds
    s_add_u32 m0, s64, 14336
    s_nop 0
    buffer_load_dwordx4 v46, s[20:23], s65 offen lds
    s_waitcnt vmcnt(18)
    s_barrier
    s_add_u32 s65, s51, 26
    s_and_b32 s65, s65, 31
    s_lshl_b32 s65, s65, 12
    s_add_u32 s65, s65, s60
    s_add_u32 m0, s63, 16384
    s_nop 0
    buffer_load_dwordx4 v6, s[44:47], s65 offen sc1 lds
    buffer_load_dwordx4 v6, s[44:47], s65 offen offset:1024 sc1 lds
    s_add_u32 s65, s51, 29
    s_and_b32 s65, s65, 31
    s_mul_i32 s65, s65, 176128
    s_add_u32 m0, s64, 24576
    s_nop 0
    buffer_load_dwordx4 v44, s[20:23], s65 offen lds
    s_add_u32 m0, s64, 25600
    s_nop 0
    buffer_load_dwordx4 v45, s[20:23], s65 offen lds
    s_add_u32 m0, s64, 26624
    s_nop 0
    buffer_load_dwordx4 v46, s[20:23], s65 offen lds
    s_waitcnt vmcnt(18)
    s_barrier
    s_add_u32 s65, s51, 27
    s_and_b32 s65, s65, 31
    s_lshl_b32 s65, s65, 12
    s_add_u32 s65, s65, s60
    s_add_u32 m0, s63, 24576
    s_nop 0
    buffer_load_dwordx4 v6, s[44:47], s65 offen sc1 lds
    buffer_load_dwordx4 v6, s[44:47], s65 offen offset:1024 sc1 lds
    s_add_u32 s65, s51, 30
    s_and_b32 s65, s65, 31
    s_mul_i32 s65, s65, 176128
    s_add_u32 m0, s64, 36864
    s_nop 0
    buffer_load_dwordx4 v44, s[20:23], s65 offen lds
    s_add_u32 m0, s64, 37888
    s_nop 0
    buffer_load_dwordx4 v45, s[20:23], s65 offen lds
    s_add_u32 m0, s64, 38912
    s_nop 0
    buffer_load_dwordx4 v46, s[20:23], s65 offen lds
    s_waitcnt vmcnt(18)
    s_barrier
    s_add_u32 s65, s51, 28
    s_and_b32 s65, s65, 31
    s_lshl_b32 s65, s65, 12
    s_add_u32 s65, s65, s60
    s_add_u32 m0, s63, 32768
    s_nop 0
    buffer_load_dwordx4 v6, s[44:47], s65 offen sc1 lds
    buffer_load_dwordx4 v6, s[44:47], s65 offen offset:1024 sc1 lds
    s_add_u32 s65, s51, 31
    s_and_b32 s65, s65, 31
    s_mul_i32 s65, s65, 176128
    s_add_u32 m0, s64, 49152
    s_nop 0
    buffer_load_dwordx4 v44, s[20:23], s65 offen lds
    s_add_u32 m0, s64, 50176
    s_nop 0
    buffer_load_dwordx4 v45, s[20:23], s65 offen lds
    s_add_u32 m0, s64, 51200
    s_nop 0
    buffer_load_dwordx4 v46, s[20:23], s65 offen lds
    s_waitcnt vmcnt(18)
    s_barrier
    s_add_u32 s65, s51, 29
    s_and_b32 s65, s65, 31
    s_lshl_b32 s65, s65, 12
    s_add_u32 s65, s65, s60
    s_add_u32 m0, s63, 40960
    s_nop 0
    buffer_load_dwordx4 v6, s[44:47], s65 offen sc1 lds
    buffer_load_dwordx4 v6, s[44:47], s65 offen offset:1024 sc1 lds
    s_waitcnt vmcnt(15)
    s_barrier
    s_add_u32 s65, s51, 30
    s_and_b32 s65, s65, 31
    s_lshl_b32 s65, s65, 12
    s_add_u32 s65, s65, s60
    s_add_u32 m0, s63, 0
    s_nop 0
    buffer_load_dwordx4 v6, s[44:47], s65 offen sc1 lds
    buffer_load_dwordx4 v6, s[44:47], s65 offen offset:1024 sc1 lds
    s_waitcnt vmcnt(12)
    s_barrier
    s_add_u32 s65, s51, 31
    s_and_b32 s65, s65, 31
    s_lshl_b32 s65, s65, 12
    s_add_u32 s65, s65, s60
    s_add_u32 m0, s63, 8192
    s_nop 0
    buffer_load_dwordx4 v6, s[44:47], s65 offen sc1 lds
    buffer_load_dwordx4 v6, s[44:47], s65 offen offset:1024 sc1 lds
    s_waitcnt vmcnt(9)
    s_barrier
    s_waitcnt vmcnt(0)
    s_barrier
    s_add_u32 s68, s97, 4
    s_and_b32 s68, s68, 7
    s_lshl_b32 s68, s68, 16
    s_add_u32 m0, s69, 65536
    s_nop 0
    buffer_load_dwordx4 v62, s[16:19], s68 offen lds
    s_add_u32 m0, s69, 66560
    s_nop 0
    buffer_load_dwordx4 v63, s[16:19], s68 offen lds
    s_add_u32 s68, s97, 5
    s_and_b32 s68, s68, 7
    s_lshl_b32 s68, s68, 16
    s_add_u32 m0, s69, 73728
    s_nop 0
    buffer_load_dwordx4 v62, s[16:19], s68 offen lds
    s_add_u32 m0, s69, 74752
    s_nop 0
    buffer_load_dwordx4 v63, s[16:19], s68 offen lds
    s_add_u32 s68, s97, 6
    s_and_b32 s68, s68, 7
    s_lshl_b32 s68, s68, 16
    s_add_u32 m0, s69, 81920
    s_nop 0
    buffer_load_dwordx4 v62, s[16:19], s68 offen lds
    s_add_u32 m0, s69, 82944
    s_nop 0
    buffer_load_dwordx4 v63, s[16:19], s68 offen lds
    s_add_u32 s68, s97, 7
    s_and_b32 s68, s68, 7
    s_lshl_b32 s68, s68, 16
    s_add_u32 m0, s69, 90112
    s_nop 0
    buffer_load_dwordx4 v62, s[16:19], s68 offen lds
    s_add_u32 m0, s69, 91136
    s_nop 0
    buffer_load_dwordx4 v63, s[16:19], s68 offen lds
    s_add_u32 s68, s3, 0
    s_cmp_ge_u32 s68, 22
    s_cselect_b32 s54, 22, 0
    s_sub_u32 s68, s68, s54
    s_lshl_b32 s68, s68, 18
    s_add_u32 m0, s69, 98304
    s_nop 0
    buffer_load_dwordx4 v60, s[28:31], s68 offen lds
    s_add_u32 m0, s69, 99328
    s_nop 0
    buffer_load_dwordx4 v61, s[28:31], s68 offen lds
    v_mov_b32 v25, 163824
    s_mov_b32 s96, 0
Lbw_9:
    ds_read_b32 v2, v25
    s_waitcnt lgkmcnt(0)
    v_readfirstlane_b32 s95, v2
    s_nop 0
    s_cmp_ge_u32 s95, 4
    s_cbranch_scc1 Lbd_10
    s_sleep 1
    s_add_u32 s96, s96, 1
    s_cmp_lt_u32 s96, 1000000
    s_cbranch_scc1 Lbw_9
Lbd_10:
    s_add_u32 s68, s97, 0
    s_and_b32 s68, s68, 7
    s_lshl_b32 s68, s68, 16
    s_add_u32 m0, s69, 32768
    s_nop 0
    buffer_load_dwordx4 v62, s[16:19], s68 offen lds
    s_add_u32 m0, s69, 33792
    s_nop 0
    buffer_load_dwordx4 v63, s[16:19], s68 offen lds
    s_add_u32 s68, s97, 1
    s_and_b32 s68, s68, 7
    s_lshl_b32 s68, s68, 16
    s_add_u32 m0, s69, 40960
    s_nop 0
    buffer_load_dwordx4 v62, s[16:19], s68 offen lds
    s_add_u32 m0, s69, 41984
    s_nop 0
    buffer_load_dwordx4 v63, s[16:19], s68 offen lds
    s_add_u32 s68, s97, 2
    s_and_b32 s68, s68, 7
    s_lshl_b32 s68, s68, 16
    s_add_u32 m0, s69, 49152
    s_nop 0
    buffer_load_dwordx4 v62, s[16:19], s68 offen lds
    s_add_u32 m0, s69, 50176
    s_nop 0
    buffer_load_dwordx4 v63, s[16:19], s68 offen lds
    s_add_u32 s68, s97, 3
    s_and_b32 s68, s68, 7
    s_lshl_b32 s68, s68, 16
    s_add_u32 m0, s69, 57344
    s_nop 0
    buffer_load_dwordx4 v62, s[16:19], s68 offen lds
    s_add_u32 m0, s69, 58368
    s_nop 0
    buffer_load_dwordx4 v63, s[16:19], s68 offen lds
    s_add_u32 s68, s3, 1
    s_cmp_ge_u32 s68, 22
    s_cselect_b32 s54, 22, 0
    s_sub_u32 s68, s68, s54
    s_lshl_b32 s68, s68, 18
    s_add_u32 m0, s69, 106496
    s_nop 0
    buffer_load_dwordx4 v60, s[28:31], s68 offen lds
    s_add_u32 m0, s69, 107520
    s_nop 0
    buffer_load_dwordx4 v61, s[28:31], s68 offen lds
    s_add_u32 s68, s3, 2
    s_cmp_ge_u32 s68, 22
    s_cselect_b32 s54, 22, 0
    s_sub_u32 s68, s68, s54
    s_lshl_b32 s68, s68, 18
    s_add_u32 m0, s69, 114688
    s_nop 0
    buffer_load_dwordx4 v60, s[28:31], s68 offen lds
    s_add_u32 m0, s69, 115712
    s_nop 0
    buffer_load_dwordx4 v61, s[28:31], s68 offen lds
    s_add_u32 s68, s3, 3
    s_cmp_ge_u32 s68, 22
    s_cselect_b32 s54, 22, 0
    s_sub_u32 s68, s68, s54
    s_lshl_b32 s68, s68, 18
    s_add_u32 m0, s69, 122880
    s_nop 0
    buffer_load_dwordx4 v60, s[28:31], s68 offen lds
    s_add_u32 m0, s69, 123904
    s_nop 0
    buffer_load_dwordx4 v61, s[28:31], s68 offen lds
    s_add_u32 s68, s3, 4
    s_cmp_ge_u32 s68, 22
    s_cselect_b32 s54, 22, 0
    s_sub_u32 s68, s68, s54
    s_lshl_b32 s68, s68, 18
    s_add_u32 m0, s69, 16384
    s_nop 0
    buffer_load_dwordx4 v60, s[28:31], s68 offen lds
    s_add_u32 m0, s69, 17408
    s_nop 0
    buffer_load_dwordx4 v61, s[28:31], s68 offen lds
    s_add_u32 s68, s3, 5
    s_cmp_ge_u32 s68, 22
    s_cselect_b32 s54, 22, 0
    s_sub_u32 s68, s68, s54
    s_lshl_b32 s68, s68, 18
    s_add_u32 m0, s69, 24576
    s_nop 0
    buffer_load_dwordx4 v60, s[28:31], s68 offen lds
    s_add_u32 m0, s69, 25600
    s_nop 0
    buffer_load_dwordx4 v61, s[28:31], s68 offen lds
    s_branch L_pload
L_bcons:
    s_lshr_b32 s58, s48, 1
    s_and_b32 s59, s48, 1
    s_waitcnt vmcnt(4)
    s_mov_b32 s96, 0
Lnp_11:
    v_readfirstlane_b32 s52, v22
    v_readfirstlane_b32 s53, v23
    s_nop 0
    s_xor_b32 s95, s52, s53
    s_cmp_eq_u32 s95, 0x5bd1e995
    s_cbranch_scc1 Lnd_12
    s_add_u32 s96, s96, 1
    s_cmp_gt_u32 s96, 20000
    s_cbranch_scc1 Lnd_12
    s_sleep 1
    buffer_load_dwordx2 v[22:23], v4, s[40:43], 0 offen sc1
    s_waitcnt vmcnt(0)
    s_branch Lnp_11
Lnd_12:
    v_mov_b32 v164, s52
    v_mov_b32 v165, s53
    v_mov_b32 v166, 0
    v_mov_b32 v167, 1
    v_mov_b32 v168, 163832
    s_waitcnt vmcnt(0)
    s_mov_b64 exec, 1
    ds_add_rtn_u32 v167, v168, v167
    s_waitcnt lgkmcnt(0)
    v_readfirstlane_b32 s95, v167
    s_nop 0
    s_cmp_lg_u32 s95, 3
    s_cbranch_scc1 Llf_13
    buffer_store_dwordx2 v[164:165], v166, s[44:47], s86 offen sc1
Llf_13:
    s_mov_b64 exec, -1
    v_lshrrev_b32 v3, 5, v1
    v_lshlrev_b32 v2, 3, v3
    s_mul_i32 s54, s57, 192
    s_mul_i32 s55, s58, 96
    s_add_u32 s54, s54, s55
    buffer_load_dwordx2 v[40:41], v2, s[24:27], s54 offen offset:0
    buffer_load_dwordx2 v[42:43], v2, s[24:27], s54 offen offset:16
    buffer_load_dwordx2 v[44:45], v2, s[24:27], s54 offen offset:32
    buffer_load_dwordx2 v[46:47], v2, s[24:27], s54 offen offset:48
    buffer_load_dwordx2 v[48:49], v2, s[24:27], s54 offen offset:64
    buffer_load_dwordx2 v[50:51], v2, s[24:27], s54 offen offset:80
    s_and_b32 s100, s49, 1
    s_lshl_b32 s100, s100, 2
    s_lshr_b32 s54, s50, 3
    s_add_u32 s100, s100, s54
    s_lshr_b32 s101, s49, 1
    s_lshl_b32 s101, s101, 3
    s_and_b32 s55, s50, 7
    s_add_u32 s101, s101, s55
    s_lshl_b32 s97, s54, 1
    s_add_u32 s97, s97, s55
    s_and_b32 s3, s49, 1
    s_add_u32 s54, s97, s3
    s_and_b32 s54, s54, 7
    s_mul_i32 s3, s54, 11
    s_lshr_b32 s3, s3, 2
    v_bfe_u32 v2, v1, 2, 2
    v_lshl_add_u32 v2, v3, 3, v2
    v_mul_u32_u24 v2, 192, v2
    v_and_b32 v5, 3, v1
    v_lshl_add_u32 v2, v5, 3, v2
    s_mul_i32 s54, s58, 6144
    v_add_u32 v2, s54, v2
    v_bfe_u32 v5, v1, 4, 1
    s_mul_i32 s54, s58, 3
    v_add_u32 v5, s54, v5
    v_add_u32 v10, 0, v5
    v_subrev_u32 v11, 6, v10
    v_min_u32 v10, v10, v11
    v_lshl_add_u32 v16, v10, 5, v2
    v_add_u32 v19, 61440, v16
    v_add_u32 v10, 2, v5
    v_subrev_u32 v11, 6, v10
    v_min_u32 v10, v10, v11
    v_lshl_add_u32 v17, v10, 5, v2
    v_add_u32 v20, 61440, v17
    v_add_u32 v10, 4, v5
    v_subrev_u32 v11, 6, v10
    v_min_u32 v10, v10, v11
    v_lshl_add_u32 v18, v10, 5, v2
    v_add_u32 v21, 61440, v18
    s_lshl_b32 s54, s59, 12
    s_lshl_b32 s55, s58, 11
    s_add_u32 s54, s54, s55
    s_add_u32 s54, s54, 110592
    v_add_u32 v22, s54, v6
    s_mul_i32 s54, s59, 6144
    v_add_u32 v2, s54, v6
    s_cmp_eq_u32 s58, 0
    s_mov_b32 s54, 0
    s_mov_b32 s55, 131072
    s_cselect_b32 s65, s54, s55
    s_cselect_b32 s66, s55, s54
    v_add_u32 v23, s65, v2
    v_add_u32 v24, s66, v2
    v_mov_b32 v25, 163824
    s_lshl_b32 s60, s56, 1
    s_add_u32 s60, s60, s59
    s_mul_i32 s60, s60, 90
    s_mul_i32 s54, s57, 6
    s_add_u32 s60, s60, s54
    s_mul_i32 s54, s58, 3
    s_add_u32 s60, s60, s54
    s_lshl_b32 s60, s60, 10
    s_add_u32 s60, s60, 6291456
    s_mul_i32 s61, s56, 15
    s_add_u32 s61, s61, s57
    s_lshl_b32 s61, s61, 7
    s_add_u32 s61, s61, 8585216
    v_mov_b32 v12, 0xbdd2d3e8
    v_mov_b32 v13, v12
    v_mov_b32 v14, 0xc0135761
    v_mov_b32 v15, v14
    v_mov_b32 v26, 1.0
    v_mov_b32 v27, 1.0
    v_and_b32 v2, 31, v1
    s_lshl_b32 s54, s48, 5
    v_add_u32 v2, s54, v2
    v_lshlrev_b32 v10, 7, v2
    v_add_u32 v10, 8519680, v10
    s_waitcnt vmcnt(0)
    v_lshlrev_b32 v64, 16, v40
    v_and_b32 v65, 0xffff0000, v40
    v_lshlrev_b32 v66, 16, v41
    v_and_b32 v67, 0xffff0000, v41
    v_lshlrev_b32 v68, 16, v42
    v_and_b32 v69, 0xffff0000, v42
    v_lshlrev_b32 v70, 16, v43
    v_and_b32 v71, 0xffff0000, v43
    v_lshlrev_b32 v72, 16, v44
    v_and_b32 v73, 0xffff0000, v44
    v_lshlrev_b32 v74, 16, v45
    v_and_b32 v75, 0xffff0000, v45
    v_lshlrev_b32 v76, 16, v46
    v_and_b32 v77, 0xffff0000, v46
    v_lshlrev_b32 v78, 16, v47
    v_and_b32 v79, 0xffff0000, v47
    v_lshlrev_b32 v80, 16, v48
    v_and_b32 v81, 0xffff0000, v48
    v_lshlrev_b32 v82, 16, v49
    v_and_b32 v83, 0xffff0000, v49
    v_lshlrev_b32 v84, 16, v50
    v_and_b32 v85, 0xffff0000, v50
    v_lshlrev_b32 v86, 16, v51
    v_and_b32 v87, 0xffff0000, v51
    v_mov_b32 v88, 0
    v_mov_b32 v89, 0
    v_mov_b32 v90, 0
    v_mov_b32 v91, 0
    v_mov_b32 v92, 0
    v_mov_b32 v93, 0
    v_mov_b32 v94, 0
    v_mov_b32 v95, 0
    v_mov_b32 v96, 0
    v_mov_b32 v97, 0
    v_mov_b32 v98, 0
    v_mov_b32 v99, 0
    v_mov_b32 v100, 0
    v_mov_b32 v101, 0
    v_mov_b32 v102, 0
    v_mov_b32 v103, 0
    v_mov_b32 v104, 0
    v_mov_b32 v105, 0
    v_mov_b32 v106, 0
    v_mov_b32 v107, 0
    v_mov_b32 v108, 0
    v_mov_b32 v109, 0
    v_mov_b32 v110, 0
    v_mov_b32 v111, 0
    v_lshrrev_b32 v2, 3, v0
    v_and_b32 v3, 7, v0
    v_lshlrev_b32 v56, 10, v2
    v_lshl_add_u32 v56, v3, 4, v56
    s_lshl_b32 s94, s101, 16
    s_lshl_b32 s54, s100, 7
    s_add_u32 s94, s94, s54
    buffer_load_dwordx4 v[36:39], v56, s[4:7], s94 offen
    v_mul_u32_u24 v57, 272, v2
    v_lshl_add_u32 v57, v3, 5, v57
    v_lshlrev_b32 v2, 1, v2
    s_lshl_b32 s54, s101, 7
    buffer_load_ushort v52, v2, s[32:35], s54 offen
    v_mov_b32 v53, 0xbfb8aa3b
    s_lshr_b32 s68, s48, 1
    s_and_b32 s69, s48, 1
    v_bfe_u32 v2, v1, 2, 2
    v_lshrrev_b32 v3, 5, v1
    v_lshl_add_u32 v28, v3, 2, v2
    v_lshlrev_b32 v28, 7, v28
    v_lshrrev_b32 v2, 1, v2
    v_lshl_add_u32 v28, v2, 6, v28
    v_bfe_u32 v2, v1, 4, 1
    v_lshl_add_u32 v28, v2, 5, v28
    v_and_b32 v2, 3, v1
    v_lshl_add_u32 v28, v2, 3, v28
    s_lshl_b32 s54, s68, 12
    v_add_u32 v28, s54, v28
    v_xor_b32 v29, 64, v28
    v_add_u32 v30, 0x10000, v28
    v_add_u32 v31, 0x10000, v29
    v_and_b32 v2, 31, v1
    v_mul_u32_u24 v2, 272, v2
    v_lshl_add_u32 v54, v3, 4, v2
    s_mul_i32 s54, s68, 17408
    v_add_u32 v54, s54, v54
    s_mul_i32 s54, s69, 8704
    v_add_u32 v54, s54, v54
    s_lshl_b32 s54, s69, 6
    v_xor_b32 v32, s54, v28
    v_add_u32 v33, 0x10000, v32
    v_add_u32 v34, 0x20000, v32
    s_lshl_b32 s54, s68, 11
    v_add_u32 v58, s54, v6
    v_add_u32 v59, 0x10000, v58
    s_mov_b32 s96, 0
    s_mov_b64 exec, 0xffffffff
Lpoll_14:
    buffer_load_dwordx2 v[8:9], v10, s[44:47], 0 offen sc1
    s_waitcnt vmcnt(0)
    v_cmp_ne_u64 vcc, s[52:53], v[8:9]
    s_add_u32 s96, s96, 1
    s_cmp_eq_u64 vcc, 0
    s_cbranch_scc1 Lpd_15
    s_mov_b64 exec, vcc
    s_cmp_gt_u32 s96, 20000
    s_cbranch_scc1 Lpd_15
    s_sleep 1
    s_branch Lpoll_14
Lpd_15:
    s_mov_b64 exec, -1
    s_barrier
    s_barrier
    ds_read_b128 v[112:115], v22 offset:0
    ds_read_b64_tr_b16 v[116:117], v16 offset:0
    ds_read_b64_tr_b16 v[118:119], v16 offset:768
    ds_read_b64_tr_b16 v[120:121], v17 offset:0
    ds_read_b64_tr_b16 v[122:123], v17 offset:768
    ds_read_b64_tr_b16 v[124:125], v18 offset:0
    ds_read_b64_tr_b16 v[126:127], v18 offset:768
    ds_read_b128 v[128:131], v22 offset:1024
    ds_read_b64_tr_b16 v[132:133], v16 offset:3072
    ds_read_b64_tr_b16 v[134:135], v16 offset:3840
    ds_read_b64_tr_b16 v[136:137], v17 offset:3072
    ds_read_b64_tr_b16 v[138:139], v17 offset:3840
    ds_read_b64_tr_b16 v[140:141], v18 offset:3072
    ds_read_b64_tr_b16 v[142:143], v18 offset:3840
    s_waitcnt lgkmcnt(7)
    v_mfma_f32_32x32x16_bf16 v[64:79], v[116:119], v[112:115], v[64:79]
    ds_read_b128 v[144:147], v22 offset:8192
    ds_read_b64_tr_b16 v[148:149], v16 offset:12288
    ds_read_b64_tr_b16 v[150:151], v16 offset:13056
    v_mfma_f32_32x32x16_bf16 v[80:95], v[120:123], v[112:115], v[80:95]
    ds_read_b64_tr_b16 v[152:153], v17 offset:12288
    ds_read_b64_tr_b16 v[154:155], v17 offset:13056
    v_mfma_f32_32x32x16_bf16 v[96:111], v[124:127], v[112:115], v[96:111]
    ds_read_b64_tr_b16 v[156:157], v18 offset:12288
    ds_read_b64_tr_b16 v[158:159], v18 offset:13056
    s_waitcnt lgkmcnt(7)
    v_mfma_f32_32x32x16_bf16 v[64:79], v[132:135], v[128:131], v[64:79]
    ds_read_b128 v[112:115], v22 offset:9216
    ds_read_b64_tr_b16 v[116:117], v16 offset:15360
    ds_read_b64_tr_b16 v[118:119], v16 offset:16128
    v_mfma_f32_32x32x16_bf16 v[80:95], v[136:139], v[128:131], v[80:95]
    ds_read_b64_tr_b16 v[120:121], v17 offset:15360
    ds_read_b64_tr_b16 v[122:123], v17 offset:16128
    v_mfma_f32_32x32x16_bf16 v[96:111], v[140:143], v[128:131], v[96:111]
    ds_read_b64_tr_b16 v[124:125], v18 offset:15360
    ds_read_b64_tr_b16 v[126:127], v18 offset:16128
    s_barrier
    s_waitcnt lgkmcnt(7)
    v_mfma_f32_32x32x16_bf16 v[64:79], v[148:151], v[144:147], v[64:79]
    ds_read_b128 v[128:131], v22 offset:16384
    ds_read_b64_tr_b16 v[132:133], v16 offset:24576
    ds_read_b64_tr_b16 v[134:135], v16 offset:25344
    v_mfma_f32_32x32x16_bf16 v[80:95], v[152:155], v[144:147], v[80:95]
    ds_read_b64_tr_b16 v[136:137], v17 offset:24576
    ds_read_b64_tr_b16 v[138:139], v17 offset:25344
    v_mfma_f32_32x32x16_bf16 v[96:111], v[156:159], v[144:147], v[96:111]
    ds_read_b64_tr_b16 v[140:141], v18 offset:24576
    ds_read_b64_tr_b16 v[142:143], v18 offset:25344
    s_waitcnt lgkmcnt(7)
    v_mfma_f32_32x32x16_bf16 v[64:79], v[116:119], v[112:115], v[64:79]
    ds_read_b128 v[144:147], v22 offset:17408
    ds_read_b64_tr_b16 v[148:149], v16 offset:27648
    ds_read_b64_tr_b16 v[150:151], v16 offset:28416
    v_mfma_f32_32x32x16_bf16 v[80:95], v[120:123], v[112:115], v[80:95]
    ds_read_b64_tr_b16 v[152:153], v17 offset:27648
    ds_read_b64_tr_b16 v[154:155], v17 offset:28416
    v_mfma_f32_32x32x16_bf16 v[96:111], v[124:127], v[112:115], v[96:111]
    ds_read_b64_tr_b16 v[156:157], v18 offset:27648
    ds_read_b64_tr_b16 v[158:159], v18 offset:28416
    s_barrier
    s_waitcnt lgkmcnt(7)
    v_mfma_f32_32x32x16_bf16 v[64:79], v[132:135], v[128:131], v[64:79]
    ds_read_b128 v[112:115], v22 offset:24576
    ds_read_b64_tr_b16 v[116:117], v16 offset:36864
    ds_read_b64_tr_b16 v[118:119], v16 offset:37632
    v_mfma_f32_32x32x16_bf16 v[80:95], v[136:139], v[128:131], v[80:95]
    ds_read_b64_tr_b16 v[120:121], v17 offset:36864
    ds_read_b64_tr_b16 v[122:123], v17 offset:37632
    v_mfma_f32_32x32x16_bf16 v[96:111], v[140:143], v[128:131], v[96:111]
    ds_read_b64_tr_b16 v[124:125], v18 offset:36864
    ds_read_b64_tr_b16 v[126:127], v18 offset:37632
    s_waitcnt lgkmcnt(7)
    v_mfma_f32_32x32x16_bf16 v[64:79], v[148:151], v[144:147], v[64:79]
    ds_read_b128 v[128:131], v22 offset:25600
    ds_read_b64_tr_b16 v[132:133], v16 offset:39936
    ds_read_b64_tr_b16 v[134:135], v16 offset:40704
    v_mfma_f32_32x32x16_bf16 v[80:95], v[152:155], v[144:147], v[80:95]
    ds_read_b64_tr_b16 v[136:137], v17 offset:39936
    ds_read_b64_tr_b16 v[138:139], v17 offset:40704
    v_mfma_f32_32x32x16_bf16 v[96:111], v[156:159], v[144:147], v[96:111]
    ds_read_b64_tr_b16 v[140:141], v18 offset:39936
    ds_read_b64_tr_b16 v[142:143], v18 offset:40704
    s_barrier
    s_waitcnt lgkmcnt(7)
    v_mfma_f32_32x32x16_bf16 v[64:79], v[116:119], v[112:115], v[64:79]
    ds_read_b128 v[144:147], v22 offset:32768
    ds_read_b64_tr_b16 v[148:149], v16 offset:49152
    ds_read_b64_tr_b16 v[150:151], v16 offset:49920
    v_mfma_f32_32x32x16_bf16 v[80:95], v[120:123], v[112:115], v[80:95]
    ds_read_b64_tr_b16 v[152:153], v17 offset:49152
    ds_read_b64_tr_b16 v[154:155], v17 offset:49920
    v_mfma_f32_32x32x16_bf16 v[96:111], v[124:127], v[112:115], v[96:111]
    ds_read_b64_tr_b16 v[156:157], v18 offset:49152
    ds_read_b64_tr_b16 v[158:159], v18 offset:49920
    s_waitcnt lgkmcnt(7)
    v_mfma_f32_32x32x16_bf16 v[64:79], v[132:135], v[128:131], v[64:79]
    ds_read_b128 v[112:115], v22 offset:33792
    ds_read_b64_tr_b16 v[116:117], v16 offset:52224
    ds_read_b64_tr_b16 v[118:119], v16 offset:52992
    v_mfma_f32_32x32x16_bf16 v[80:95], v[136:139], v[128:131], v[80:95]
    ds_read_b64_tr_b16 v[120:121], v17 offset:52224
    ds_read_b64_tr_b16 v[122:123], v17 offset:52992
    v_mfma_f32_32x32x16_bf16 v[96:111], v[140:143], v[128:131], v[96:111]
    ds_read_b64_tr_b16 v[124:125], v18 offset:52224
    ds_read_b64_tr_b16 v[126:127], v18 offset:52992
    s_barrier
    s_waitcnt lgkmcnt(7)
    v_mfma_f32_32x32x16_bf16 v[64:79], v[148:151], v[144:147], v[64:79]
    ds_read_b128 v[128:131], v22 offset:40960
    ds_read_b64_tr_b16 v[132:133], v19 offset:0
    ds_read_b64_tr_b16 v[134:135], v19 offset:768
    v_mfma_f32_32x32x16_bf16 v[80:95], v[152:155], v[144:147], v[80:95]
    ds_read_b64_tr_b16 v[136:137], v20 offset:0
    ds_read_b64_tr_b16 v[138:139], v20 offset:768
    v_mfma_f32_32x32x16_bf16 v[96:111], v[156:159], v[144:147], v[96:111]
    ds_read_b64_tr_b16 v[140:141], v21 offset:0
    ds_read_b64_tr_b16 v[142:143], v21 offset:768
    s_waitcnt lgkmcnt(7)
    v_mfma_f32_32x32x16_bf16 v[64:79], v[116:119], v[112:115], v[64:79]
    ds_read_b128 v[144:147], v22 offset:41984
    ds_read_b64_tr_b16 v[148:149], v19 offset:3072
    ds_read_b64_tr_b16 v[150:151], v19 offset:3840
    v_mfma_f32_32x32x16_bf16 v[80:95], v[120:123], v[112:115], v[80:95]
    ds_read_b64_tr_b16 v[152:153], v20 offset:3072
    ds_read_b64_tr_b16 v[154:155], v20 offset:3840
    v_mfma_f32_32x32x16_bf16 v[96:111], v[124:127], v[112:115], v[96:111]
    ds_read_b64_tr_b16 v[156:157], v21 offset:3072
    ds_read_b64_tr_b16 v[158:159], v21 offset:3840
    s_barrier
    s_waitcnt lgkmcnt(7)
    v_mfma_f32_32x32x16_bf16 v[64:79], v[132:135], v[128:131], v[64:79]
    ds_read_b128 v[112:115], v22 offset:0
    ds_read_b64_tr_b16 v[116:117], v19 offset:12288
    ds_read_b64_tr_b16 v[118:119], v19 offset:13056
    v_mfma_f32_32x32x16_bf16 v[80:95], v[136:139], v[128:131], v[80:95]
    ds_read_b64_tr_b16 v[120:121], v20 offset:12288
    ds_read_b64_tr_b16 v[122:123], v20 offset:13056
    v_mfma_f32_32x32x16_bf16 v[96:111], v[140:143], v[128:131], v[96:111]
    ds_read_b64_tr_b16 v[124:125], v21 offset:12288
    ds_read_b64_tr_b16 v[126:127], v21 offset:13056
    s_waitcnt lgkmcnt(7)
    v_mfma_f32_32x32x16_bf16 v[64:79], v[148:151], v[144:147], v[64:79]
    ds_read_b128 v[128:131], v22 offset:1024
    ds_read_b64_tr_b16 v[132:133], v19 offset:15360
    ds_read_b64_tr_b16 v[134:135], v19 offset:16128
    v_mfma_f32_32x32x16_bf16 v[80:95], v[152:155], v[144:147], v[80:95]
    ds_read_b64_tr_b16 v[136:137], v20 offset:15360
    ds_read_b64_tr_b16 v[138:139], v20 offset:16128
    v_mfma_f32_32x32x16_bf16 v[96:111], v[156:159], v[144:147], v[96:111]
    ds_read_b64_tr_b16 v[140:141], v21 offset:15360
    ds_read_b64_tr_b16 v[142:143], v21 offset:16128
    s_barrier
    s_waitcnt lgkmcnt(7)
    v_mfma_f32_32x32x16_bf16 v[64:79], v[116:119], v[112:115], v[64:79]
    ds_read_b128 v[144:147], v22 offset:8192
    ds_read_b64_tr_b16 v[148:149], v19 offset:24576
    ds_read_b64_tr_b16 v[150:151], v19 offset:25344
    v_mfma_f32_32x32x16_bf16 v[80:95], v[120:123], v[112:115], v[80:95]
    ds_read_b64_tr_b16 v[152:153], v20 offset:24576
    ds_read_b64_tr_b16 v[154:155], v20 offset:25344
    v_mfma_f32_32x32x16_bf16 v[96:111], v[124:127], v[112:115], v[96:111]
    ds_read_b64_tr_b16 v[156:157], v21 offset:24576
    ds_read_b64_tr_b16 v[158:159], v21 offset:25344
    s_waitcnt lgkmcnt(7)
    v_mfma_f32_32x32x16_bf16 v[64:79], v[132:135], v[128:131], v[64:79]
    ds_read_b128 v[112:115], v22 offset:9216
    ds_read_b64_tr_b16 v[116:117], v19 offset:27648
    ds_read_b64_tr_b16 v[118:119], v19 offset:28416
    v_mfma_f32_32x32x16_bf16 v[80:95], v[136:139], v[128:131], v[80:95]
    ds_read_b64_tr_b16 v[120:121], v20 offset:27648
    ds_read_b64_tr_b16 v[122:123], v20 offset:28416
    v_mfma_f32_32x32x16_bf16 v[96:111], v[140:143], v[128:131], v[96:111]
    ds_read_b64_tr_b16 v[124:125], v21 offset:27648
    ds_read_b64_tr_b16 v[126:127], v21 offset:28416
    s_barrier
    s_waitcnt lgkmcnt(7)
    v_mfma_f32_32x32x16_bf16 v[64:79], v[148:151], v[144:147], v[64:79]
    ds_read_b128 v[128:131], v22 offset:16384
    ds_read_b64_tr_b16 v[132:133], v19 offset:36864
    ds_read_b64_tr_b16 v[134:135], v19 offset:37632
    v_mfma_f32_32x32x16_bf16 v[80:95], v[152:155], v[144:147], v[80:95]
    ds_read_b64_tr_b16 v[136:137], v20 offset:36864
    ds_read_b64_tr_b16 v[138:139], v20 offset:37632
    v_mfma_f32_32x32x16_bf16 v[96:111], v[156:159], v[144:147], v[96:111]
    ds_read_b64_tr_b16 v[140:141], v21 offset:36864
    ds_read_b64_tr_b16 v[142:143], v21 offset:37632
    s_waitcnt lgkmcnt(7)
    v_mfma_f32_32x32x16_bf16 v[64:79], v[116:119], v[112:115], v[64:79]
    ds_read_b128 v[144:147], v22 offset:17408
    ds_read_b64_tr_b16 v[148:149], v19 offset:39936
    ds_read_b64_tr_b16 v[150:151], v19 offset:40704
    v_mfma_f32_32x32x16_bf16 v[80:95], v[120:123], v[112:115], v[80:95]
    ds_read_b64_tr_b16 v[152:153], v20 offset:39936
    ds_read_b64_tr_b16 v[154:155], v20 offset:40704
    v_mfma_f32_32x32x16_bf16 v[96:111], v[124:127], v[112:115], v[96:111]
    ds_read_b64_tr_b16 v[156:157], v21 offset:39936
    ds_read_b64_tr_b16 v[158:159], v21 offset:40704
    s_barrier
    s_waitcnt lgkmcnt(7)
    v_mfma_f32_32x32x16_bf16 v[64:79], v[132:135], v[128:131], v[64:79]
    ds_read_b128 v[112:115], v22 offset:24576
    ds_read_b64_tr_b16 v[116:117], v16 offset:0
    ds_read_b64_tr_b16 v[118:119], v16 offset:768
    v_mfma_f32_32x32x16_bf16 v[80:95], v[136:139], v[128:131], v[80:95]
    ds_read_b64_tr_b16 v[120:121], v17 offset:0
    ds_read_b64_tr_b16 v[122:123], v17 offset:768
    v_mfma_f32_32x32x16_bf16 v[96:111], v[140:143], v[128:131], v[96:111]
    ds_read_b64_tr_b16 v[124:125], v18 offset:0
    ds_read_b64_tr_b16 v[126:127], v18 offset:768
    s_waitcnt lgkmcnt(7)
    v_mfma_f32_32x32x16_bf16 v[64:79], v[148:151], v[144:147], v[64:79]
    ds_read_b128 v[128:131], v22 offset:25600
    ds_read_b64_tr_b16 v[132:133], v16 offset:3072
    ds_read_b64_tr_b16 v[134:135], v16 offset:3840
    v_mfma_f32_32x32x16_bf16 v[80:95], v[152:155], v[144:147], v[80:95]
    ds_read_b64_tr_b16 v[136:137], v17 offset:3072
    ds_read_b64_tr_b16 v[138:139], v17 offset:3840
    v_mfma_f32_32x32x16_bf16 v[96:111], v[156:159], v[144:147], v[96:111]
    ds_read_b64_tr_b16 v[140:141], v18 offset:3072
    ds_read_b64_tr_b16 v[142:143], v18 offset:3840
    s_barrier
    s_waitcnt lgkmcnt(7)
    v_mfma_f32_32x32x16_bf16 v[64:79], v[116:119], v[112:115], v[64:79]
    ds_read_b128 v[144:147], v22 offset:32768
    ds_read_b64_tr_b16 v[148:149], v16 offset:12288
    ds_read_b64_tr_b16 v[150:151], v16 offset:13056
    v_mfma_f32_32x32x16_bf16 v[80:95], v[120:123], v[112:115], v[80:95]
    ds_read_b64_tr_b16 v[152:153], v17 offset:12288
    ds_read_b64_tr_b16 v[154:155], v17 offset:13056
    v_mfma_f32_32x32x16_bf16 v[96:111], v[124:127], v[112:115], v[96:111]
    ds_read_b64_tr_b16 v[156:157], v18 offset:12288
    ds_read_b64_tr_b16 v[158:159], v18 offset:13056
    s_waitcnt lgkmcnt(7)
    v_mfma_f32_32x32x16_bf16 v[64:79], v[132:135], v[128:131], v[64:79]
    ds_read_b128 v[112:115], v22 offset:33792
    ds_read_b64_tr_b16 v[116:117], v16 offset:15360
    ds_read_b64_tr_b16 v[118:119], v16 offset:16128
    v_mfma_f32_32x32x16_bf16 v[80:95], v[136:139], v[128:131], v[80:95]
    ds_read_b64_tr_b16 v[120:121], v17 offset:15360
    ds_read_b64_tr_b16 v[122:123], v17 offset:16128
    v_mfma_f32_32x32x16_bf16 v[96:111], v[140:143], v[128:131], v[96:111]
    ds_read_b64_tr_b16 v[124:125], v18 offset:15360
    ds_read_b64_tr_b16 v[126:127], v18 offset:16128
    s_barrier
    s_waitcnt lgkmcnt(7)
    v_mfma_f32_32x32x16_bf16 v[64:79], v[148:151], v[144:147], v[64:79]
    ds_read_b128 v[128:131], v22 offset:40960
    ds_read_b64_tr_b16 v[132:133], v16 offset:24576
    ds_read_b64_tr_b16 v[134:135], v16 offset:25344
    v_mfma_f32_32x32x16_bf16 v[80:95], v[152:155], v[144:147], v[80:95]
    ds_read_b64_tr_b16 v[136:137], v17 offset:24576
    ds_read_b64_tr_b16 v[138:139], v17 offset:25344
    v_mfma_f32_32x32x16_bf16 v[96:111], v[156:159], v[144:147], v[96:111]
    ds_read_b64_tr_b16 v[140:141], v18 offset:24576
    ds_read_b64_tr_b16 v[142:143], v18 offset:25344
    s_waitcnt lgkmcnt(7)
    v_mfma_f32_32x32x16_bf16 v[64:79], v[116:119], v[112:115], v[64:79]
    ds_read_b128 v[144:147], v22 offset:41984
    ds_read_b64_tr_b16 v[148:149], v16 offset:27648
    ds_read_b64_tr_b16 v[150:151], v16 offset:28416
    v_mfma_f32_32x32x16_bf16 v[80:95], v[120:123], v[112:115], v[80:95]
    ds_read_b64_tr_b16 v[152:153], v17 offset:27648
    ds_read_b64_tr_b16 v[154:155], v17 offset:28416
    v_mfma_f32_32x32x16_bf16 v[96:111], v[124:127], v[112:115], v[96:111]
    ds_read_b64_tr_b16 v[156:157], v18 offset:27648
    ds_read_b64_tr_b16 v[158:159], v18 offset:28416
    s_barrier
    s_waitcnt lgkmcnt(7)
    v_mfma_f32_32x32x16_bf16 v[64:79], v[132:135], v[128:131], v[64:79]
    ds_read_b128 v[112:115], v22 offset:0
    ds_read_b64_tr_b16 v[116:117], v16 offset:36864
    ds_read_b64_tr_b16 v[118:119], v16 offset:37632
    v_mfma_f32_32x32x16_bf16 v[80:95], v[136:139], v[128:131], v[80:95]
    ds_read_b64_tr_b16 v[120:121], v17 offset:36864
    ds_read_b64_tr_b16 v[122:123], v17 offset:37632
    v_mfma_f32_32x32x16_bf16 v[96:111], v[140:143], v[128:131], v[96:111]
    ds_read_b64_tr_b16 v[124:125], v18 offset:36864
    ds_read_b64_tr_b16 v[126:127], v18 offset:37632
    s_waitcnt lgkmcnt(7)
    v_mfma_f32_32x32x16_bf16 v[64:79], v[148:151], v[144:147], v[64:79]
    ds_read_b128 v[128:131], v22 offset:1024
    ds_read_b64_tr_b16 v[132:133], v16 offset:39936
    ds_read_b64_tr_b16 v[134:135], v16 offset:40704
    v_mfma_f32_32x32x16_bf16 v[80:95], v[152:155], v[144:147], v[80:95]
    ds_read_b64_tr_b16 v[136:137], v17 offset:39936
    ds_read_b64_tr_b16 v[138:139], v17 offset:40704
    v_mfma_f32_32x32x16_bf16 v[96:111], v[156:159], v[144:147], v[96:111]
    ds_read_b64_tr_b16 v[140:141], v18 offset:39936
    ds_read_b64_tr_b16 v[142:143], v18 offset:40704
    s_barrier
    s_waitcnt lgkmcnt(7)
    v_mfma_f32_32x32x16_bf16 v[64:79], v[116:119], v[112:115], v[64:79]
    ds_read_b128 v[144:147], v22 offset:8192
    ds_read_b64_tr_b16 v[148:149], v16 offset:49152
    ds_read_b64_tr_b16 v[150:151], v16 offset:49920
    v_mfma_f32_32x32x16_bf16 v[80:95], v[120:123], v[112:115], v[80:95]
    ds_read_b64_tr_b16 v[152:153], v17 offset:49152
    ds_read_b64_tr_b16 v[154:155], v17 offset:49920
    v_mfma_f32_32x32x16_bf16 v[96:111], v[124:127], v[112:115], v[96:111]
    ds_read_b64_tr_b16 v[156:157], v18 offset:49152
    ds_read_b64_tr_b16 v[158:159], v18 offset:49920
    s_waitcnt lgkmcnt(7)
    v_mfma_f32_32x32x16_bf16 v[64:79], v[132:135], v[128:131], v[64:79]
    ds_read_b128 v[112:115], v22 offset:9216
    ds_read_b64_tr_b16 v[116:117], v16 offset:52224
    ds_read_b64_tr_b16 v[118:119], v16 offset:52992
    v_mfma_f32_32x32x16_bf16 v[80:95], v[136:139], v[128:131], v[80:95]
    ds_read_b64_tr_b16 v[120:121], v17 offset:52224
    ds_read_b64_tr_b16 v[122:123], v17 offset:52992
    v_mfma_f32_32x32x16_bf16 v[96:111], v[140:143], v[128:131], v[96:111]
    ds_read_b64_tr_b16 v[124:125], v18 offset:52224
    ds_read_b64_tr_b16 v[126:127], v18 offset:52992
    s_barrier
    s_waitcnt lgkmcnt(7)
    v_mfma_f32_32x32x16_bf16 v[64:79], v[148:151], v[144:147], v[64:79]
    ds_read_b128 v[128:131], v22 offset:16384
    ds_read_b64_tr_b16 v[132:133], v19 offset:0
    ds_read_b64_tr_b16 v[134:135], v19 offset:768
    v_mfma_f32_32x32x16_bf16 v[80:95], v[152:155], v[144:147], v[80:95]
    ds_read_b64_tr_b16 v[136:137], v20 offset:0
    ds_read_b64_tr_b16 v[138:139], v20 offset:768
    v_mfma_f32_32x32x16_bf16 v[96:111], v[156:159], v[144:147], v[96:111]
    ds_read_b64_tr_b16 v[140:141], v21 offset:0
    ds_read_b64_tr_b16 v[142:143], v21 offset:768
    s_waitcnt lgkmcnt(7)
    v_mfma_f32_32x32x16_bf16 v[64:79], v[116:119], v[112:115], v[64:79]
    ds_read_b128 v[144:147], v22 offset:17408
    ds_read_b64_tr_b16 v[148:149], v19 offset:3072
    ds_read_b64_tr_b16 v[150:151], v19 offset:3840
    v_mfma_f32_32x32x16_bf16 v[80:95], v[120:123], v[112:115], v[80:95]
    ds_read_b64_tr_b16 v[152:153], v20 offset:3072
    ds_read_b64_tr_b16 v[154:155], v20 offset:3840
    v_mfma_f32_32x32x16_bf16 v[96:111], v[124:127], v[112:115], v[96:111]
    ds_read_b64_tr_b16 v[156:157], v21 offset:3072
    ds_read_b64_tr_b16 v[158:159], v21 offset:3840
    s_barrier
    s_waitcnt lgkmcnt(7)
    v_mfma_f32_32x32x16_bf16 v[64:79], v[132:135], v[128:131], v[64:79]
    ds_read_b128 v[112:115], v22 offset:24576
    ds_read_b64_tr_b16 v[116:117], v19 offset:12288
    ds_read_b64_tr_b16 v[118:119], v19 offset:13056
    v_mfma_f32_32x32x16_bf16 v[80:95], v[136:139], v[128:131], v[80:95]
    ds_read_b64_tr_b16 v[120:121], v20 offset:12288
    ds_read_b64_tr_b16 v[122:123], v20 offset:13056
    v_mfma_f32_32x32x16_bf16 v[96:111], v[140:143], v[128:131], v[96:111]
    ds_read_b64_tr_b16 v[124:125], v21 offset:12288
    ds_read_b64_tr_b16 v[126:127], v21 offset:13056
    s_waitcnt lgkmcnt(7)
    v_mfma_f32_32x32x16_bf16 v[64:79], v[148:151], v[144:147], v[64:79]
    ds_read_b128 v[128:131], v22 offset:25600
    ds_read_b64_tr_b16 v[132:133], v19 offset:15360
    ds_read_b64_tr_b16 v[134:135], v19 offset:16128
    v_mfma_f32_32x32x16_bf16 v[80:95], v[152:155], v[144:147], v[80:95]
    ds_read_b64_tr_b16 v[136:137], v20 offset:15360
    ds_read_b64_tr_b16 v[138:139], v20 offset:16128
    v_mfma_f32_32x32x16_bf16 v[96:111], v[156:159], v[144:147], v[96:111]
    ds_read_b64_tr_b16 v[140:141], v21 offset:15360
    ds_read_b64_tr_b16 v[142:143], v21 offset:16128
    s_barrier
    s_waitcnt lgkmcnt(7)
    v_mfma_f32_32x32x16_bf16 v[64:79], v[116:119], v[112:115], v[64:79]
    ds_read_b128 v[144:147], v22 offset:32768
    ds_read_b64_tr_b16 v[148:149], v19 offset:24576
    ds_read_b64_tr_b16 v[150:151], v19 offset:25344
    v_mfma_f32_32x32x16_bf16 v[80:95], v[120:123], v[112:115], v[80:95]
    ds_read_b64_tr_b16 v[152:153], v20 offset:24576
    ds_read_b64_tr_b16 v[154:155], v20 offset:25344
    v_mfma_f32_32x32x16_bf16 v[96:111], v[124:127], v[112:115], v[96:111]
    ds_read_b64_tr_b16 v[156:157], v21 offset:24576
    ds_read_b64_tr_b16 v[158:159], v21 offset:25344
    s_waitcnt lgkmcnt(7)
    v_mfma_f32_32x32x16_bf16 v[64:79], v[132:135], v[128:131], v[64:79]
    ds_read_b128 v[112:115], v22 offset:33792
    ds_read_b64_tr_b16 v[116:117], v19 offset:27648
    ds_read_b64_tr_b16 v[118:119], v19 offset:28416
    v_mfma_f32_32x32x16_bf16 v[80:95], v[136:139], v[128:131], v[80:95]
    ds_read_b64_tr_b16 v[120:121], v20 offset:27648
    ds_read_b64_tr_b16 v[122:123], v20 offset:28416
    v_mfma_f32_32x32x16_bf16 v[96:111], v[140:143], v[128:131], v[96:111]
    ds_read_b64_tr_b16 v[124:125], v21 offset:27648
    ds_read_b64_tr_b16 v[126:127], v21 offset:28416
    s_barrier
    s_waitcnt lgkmcnt(7)
    v_mfma_f32_32x32x16_bf16 v[64:79], v[148:151], v[144:147], v[64:79]
    ds_read_b128 v[128:131], v22 offset:40960
    ds_read_b64_tr_b16 v[132:133], v19 offset:36864
    ds_read_b64_tr_b16 v[134:135], v19 offset:37632
    v_mfma_f32_32x32x16_bf16 v[80:95], v[152:155], v[144:147], v[80:95]
    ds_read_b64_tr_b16 v[136:137], v20 offset:36864
    ds_read_b64_tr_b16 v[138:139], v20 offset:37632
    v_mfma_f32_32x32x16_bf16 v[96:111], v[156:159], v[144:147], v[96:111]
    ds_read_b64_tr_b16 v[140:141], v21 offset:36864
    ds_read_b64_tr_b16 v[142:143], v21 offset:37632
    s_waitcnt lgkmcnt(7)
    v_mfma_f32_32x32x16_bf16 v[64:79], v[116:119], v[112:115], v[64:79]
    ds_read_b128 v[144:147], v22 offset:41984
    ds_read_b64_tr_b16 v[148:149], v19 offset:39936
    ds_read_b64_tr_b16 v[150:151], v19 offset:40704
    v_mfma_f32_32x32x16_bf16 v[80:95], v[120:123], v[112:115], v[80:95]
    ds_read_b64_tr_b16 v[152:153], v20 offset:39936
    ds_read_b64_tr_b16 v[154:155], v20 offset:40704
    v_mfma_f32_32x32x16_bf16 v[96:111], v[124:127], v[112:115], v[96:111]
    ds_read_b64_tr_b16 v[156:157], v21 offset:39936
    ds_read_b64_tr_b16 v[158:159], v21 offset:40704
    s_barrier
    s_waitcnt lgkmcnt(7)
    v_mfma_f32_32x32x16_bf16 v[64:79], v[132:135], v[128:131], v[64:79]
    ds_read_b128 v[112:115], v22 offset:0
    ds_read_b64_tr_b16 v[116:117], v16 offset:0
    ds_read_b64_tr_b16 v[118:119], v16 offset:768
    v_mfma_f32_32x32x16_bf16 v[80:95], v[136:139], v[128:131], v[80:95]
    ds_read_b64_tr_b16 v[120:121], v17 offset:0
    ds_read_b64_tr_b16 v[122:123], v17 offset:768
    v_mfma_f32_32x32x16_bf16 v[96:111], v[140:143], v[128:131], v[96:111]
    ds_read_b64_tr_b16 v[124:125], v18 offset:0
    ds_read_b64_tr_b16 v[126:127], v18 offset:768
    s_waitcnt lgkmcnt(7)
    v_mfma_f32_32x32x16_bf16 v[64:79], v[148:151], v[144:147], v[64:79]
    ds_read_b128 v[128:131], v22 offset:1024
    ds_read_b64_tr_b16 v[132:133], v16 offset:3072
    ds_read_b64_tr_b16 v[134:135], v16 offset:3840
    v_mfma_f32_32x32x16_bf16 v[80:95], v[152:155], v[144:147], v[80:95]
    ds_read_b64_tr_b16 v[136:137], v17 offset:3072
    ds_read_b64_tr_b16 v[138:139], v17 offset:3840
    v_mfma_f32_32x32x16_bf16 v[96:111], v[156:159], v[144:147], v[96:111]
    ds_read_b64_tr_b16 v[140:141], v18 offset:3072
    ds_read_b64_tr_b16 v[142:143], v18 offset:3840
    s_barrier
    s_waitcnt lgkmcnt(7)
    v_mfma_f32_32x32x16_bf16 v[64:79], v[116:119], v[112:115], v[64:79]
    ds_read_b128 v[144:147], v22 offset:8192
    ds_read_b64_tr_b16 v[148:149], v16 offset:12288
    ds_read_b64_tr_b16 v[150:151], v16 offset:13056
    v_mfma_f32_32x32x16_bf16 v[80:95], v[120:123], v[112:115], v[80:95]
    ds_read_b64_tr_b16 v[152:153], v17 offset:12288
    ds_read_b64_tr_b16 v[154:155], v17 offset:13056
    v_mfma_f32_32x32x16_bf16 v[96:111], v[124:127], v[112:115], v[96:111]
    ds_read_b64_tr_b16 v[156:157], v18 offset:12288
    ds_read_b64_tr_b16 v[158:159], v18 offset:13056
    s_waitcnt lgkmcnt(7)
    v_mfma_f32_32x32x16_bf16 v[64:79], v[132:135], v[128:131], v[64:79]
    ds_read_b128 v[112:115], v22 offset:9216
    ds_read_b64_tr_b16 v[116:117], v16 offset:15360
    ds_read_b64_tr_b16 v[118:119], v16 offset:16128
    v_mfma_f32_32x32x16_bf16 v[80:95], v[136:139], v[128:131], v[80:95]
    ds_read_b64_tr_b16 v[120:121], v17 offset:15360
    ds_read_b64_tr_b16 v[122:123], v17 offset:16128
    v_mfma_f32_32x32x16_bf16 v[96:111], v[140:143], v[128:131], v[96:111]
    ds_read_b64_tr_b16 v[124:125], v18 offset:15360
    ds_read_b64_tr_b16 v[126:127], v18 offset:16128
    s_barrier
    s_waitcnt lgkmcnt(7)
    v_mfma_f32_32x32x16_bf16 v[64:79], v[148:151], v[144:147], v[64:79]
    ds_read_b128 v[128:131], v22 offset:16384
    ds_read_b64_tr_b16 v[132:133], v16 offset:24576
    ds_read_b64_tr_b16 v[134:135], v16 offset:25344
    v_mfma_f32_32x32x16_bf16 v[80:95], v[152:155], v[144:147], v[80:95]
    ds_read_b64_tr_b16 v[136:137], v17 offset:24576
    ds_read_b64_tr_b16 v[138:139], v17 offset:25344
    v_mfma_f32_32x32x16_bf16 v[96:111], v[156:159], v[144:147], v[96:111]
    ds_read_b64_tr_b16 v[140:141], v18 offset:24576
    ds_read_b64_tr_b16 v[142:143], v18 offset:25344
    s_waitcnt lgkmcnt(7)
    v_mfma_f32_32x32x16_bf16 v[64:79], v[116:119], v[112:115], v[64:79]
    ds_read_b128 v[144:147], v22 offset:17408
    ds_read_b64_tr_b16 v[148:149], v16 offset:27648
    ds_read_b64_tr_b16 v[150:151], v16 offset:28416
    v_mfma_f32_32x32x16_bf16 v[80:95], v[120:123], v[112:115], v[80:95]
    ds_read_b64_tr_b16 v[152:153], v17 offset:27648
    ds_read_b64_tr_b16 v[154:155], v17 offset:28416
    v_mfma_f32_32x32x16_bf16 v[96:111], v[124:127], v[112:115], v[96:111]
    ds_read_b64_tr_b16 v[156:157], v18 offset:27648
    ds_read_b64_tr_b16 v[158:159], v18 offset:28416
    s_barrier
    s_waitcnt lgkmcnt(7)
    v_mfma_f32_32x32x16_bf16 v[64:79], v[132:135], v[128:131], v[64:79]
    ds_read_b128 v[112:115], v22 offset:24576
    ds_read_b64_tr_b16 v[116:117], v16 offset:36864
    ds_read_b64_tr_b16 v[118:119], v16 offset:37632
    v_mfma_f32_32x32x16_bf16 v[80:95], v[136:139], v[128:131], v[80:95]
    ds_read_b64_tr_b16 v[120:121], v17 offset:36864
    ds_read_b64_tr_b16 v[122:123], v17 offset:37632
    v_mfma_f32_32x32x16_bf16 v[96:111], v[140:143], v[128:131], v[96:111]
    ds_read_b64_tr_b16 v[124:125], v18 offset:36864
    ds_read_b64_tr_b16 v[126:127], v18 offset:37632
    s_waitcnt lgkmcnt(7)
    v_mfma_f32_32x32x16_bf16 v[64:79], v[148:151], v[144:147], v[64:79]
    ds_read_b128 v[128:131], v22 offset:25600
    ds_read_b64_tr_b16 v[132:133], v16 offset:39936
    ds_read_b64_tr_b16 v[134:135], v16 offset:40704
    v_mfma_f32_32x32x16_bf16 v[80:95], v[152:155], v[144:147], v[80:95]
    ds_read_b64_tr_b16 v[136:137], v17 offset:39936
    ds_read_b64_tr_b16 v[138:139], v17 offset:40704
    v_mfma_f32_32x32x16_bf16 v[96:111], v[156:159], v[144:147], v[96:111]
    ds_read_b64_tr_b16 v[140:141], v18 offset:39936
    ds_read_b64_tr_b16 v[142:143], v18 offset:40704
    s_barrier
    s_waitcnt lgkmcnt(7)
    v_mfma_f32_32x32x16_bf16 v[64:79], v[116:119], v[112:115], v[64:79]
    ds_read_b128 v[144:147], v22 offset:32768
    ds_read_b64_tr_b16 v[148:149], v16 offset:49152
    ds_read_b64_tr_b16 v[150:151], v16 offset:49920
    v_mfma_f32_32x32x16_bf16 v[80:95], v[120:123], v[112:115], v[80:95]
    ds_read_b64_tr_b16 v[152:153], v17 offset:49152
    ds_read_b64_tr_b16 v[154:155], v17 offset:49920
    v_mfma_f32_32x32x16_bf16 v[96:111], v[124:127], v[112:115], v[96:111]
    ds_read_b64_tr_b16 v[156:157], v18 offset:49152
    ds_read_b64_tr_b16 v[158:159], v18 offset:49920
    s_waitcnt lgkmcnt(7)
    v_mfma_f32_32x32x16_bf16 v[64:79], v[132:135], v[128:131], v[64:79]
    ds_read_b128 v[112:115], v22 offset:33792
    ds_read_b64_tr_b16 v[116:117], v16 offset:52224
    ds_read_b64_tr_b16 v[118:119], v16 offset:52992
    v_mfma_f32_32x32x16_bf16 v[80:95], v[136:139], v[128:131], v[80:95]
    ds_read_b64_tr_b16 v[120:121], v17 offset:52224
    ds_read_b64_tr_b16 v[122:123], v17 offset:52992
    v_mfma_f32_32x32x16_bf16 v[96:111], v[140:143], v[128:131], v[96:111]
    ds_read_b64_tr_b16 v[124:125], v18 offset:52224
    ds_read_b64_tr_b16 v[126:127], v18 offset:52992
    s_barrier
    s_waitcnt lgkmcnt(7)
    v_mfma_f32_32x32x16_bf16 v[64:79], v[148:151], v[144:147], v[64:79]
    ds_read_b128 v[128:131], v22 offset:40960
    ds_read_b64_tr_b16 v[132:133], v19 offset:0
    ds_read_b64_tr_b16 v[134:135], v19 offset:768
    v_mfma_f32_32x32x16_bf16 v[80:95], v[152:155], v[144:147], v[80:95]
    ds_read_b64_tr_b16 v[136:137], v20 offset:0
    ds_read_b64_tr_b16 v[138:139], v20 offset:768
    v_mfma_f32_32x32x16_bf16 v[96:111], v[156:159], v[144:147], v[96:111]
    ds_read_b64_tr_b16 v[140:141], v21 offset:0
    ds_read_b64_tr_b16 v[142:143], v21 offset:768
    s_waitcnt lgkmcnt(7)
    v_mfma_f32_32x32x16_bf16 v[64:79], v[116:119], v[112:115], v[64:79]
    ds_read_b128 v[144:147], v22 offset:41984
    ds_read_b64_tr_b16 v[148:149], v19 offset:3072
    ds_read_b64_tr_b16 v[150:151], v19 offset:3840
    v_mfma_f32_32x32x16_bf16 v[80:95], v[120:123], v[112:115], v[80:95]
    ds_read_b64_tr_b16 v[152:153], v20 offset:3072
    ds_read_b64_tr_b16 v[154:155], v20 offset:3840
    v_mfma_f32_32x32x16_bf16 v[96:111], v[124:127], v[112:115], v[96:111]
    ds_read_b64_tr_b16 v[156:157], v21 offset:3072
    ds_read_b64_tr_b16 v[158:159], v21 offset:3840
    s_barrier
    s_waitcnt lgkmcnt(7)
    v_mfma_f32_32x32x16_bf16 v[64:79], v[132:135], v[128:131], v[64:79]
    ds_read_b128 v[112:115], v22 offset:0
    ds_read_b64_tr_b16 v[116:117], v19 offset:12288
    ds_read_b64_tr_b16 v[118:119], v19 offset:13056
    v_mfma_f32_32x32x16_bf16 v[80:95], v[136:139], v[128:131], v[80:95]
    ds_read_b64_tr_b16 v[120:121], v20 offset:12288
    ds_read_b64_tr_b16 v[122:123], v20 offset:13056
    v_mfma_f32_32x32x16_bf16 v[96:111], v[140:143], v[128:131], v[96:111]
    ds_read_b64_tr_b16 v[124:125], v21 offset:12288
    ds_read_b64_tr_b16 v[126:127], v21 offset:13056
    s_waitcnt lgkmcnt(7)
    v_mfma_f32_32x32x16_bf16 v[64:79], v[148:151], v[144:147], v[64:79]
    ds_read_b128 v[128:131], v22 offset:1024
    ds_read_b64_tr_b16 v[132:133], v19 offset:15360
    ds_read_b64_tr_b16 v[134:135], v19 offset:16128
    v_mfma_f32_32x32x16_bf16 v[80:95], v[152:155], v[144:147], v[80:95]
    ds_read_b64_tr_b16 v[136:137], v20 offset:15360
    ds_read_b64_tr_b16 v[138:139], v20 offset:16128
    v_mfma_f32_32x32x16_bf16 v[96:111], v[156:159], v[144:147], v[96:111]
    ds_read_b64_tr_b16 v[140:141], v21 offset:15360
    ds_read_b64_tr_b16 v[142:143], v21 offset:16128
    s_barrier
    s_waitcnt lgkmcnt(7)
    v_mfma_f32_32x32x16_bf16 v[64:79], v[116:119], v[112:115], v[64:79]
    ds_read_b128 v[144:147], v22 offset:8192
    ds_read_b64_tr_b16 v[148:149], v19 offset:24576
    ds_read_b64_tr_b16 v[150:151], v19 offset:25344
    v_mfma_f32_32x32x16_bf16 v[80:95], v[120:123], v[112:115], v[80:95]
    ds_read_b64_tr_b16 v[152:153], v20 offset:24576
    ds_read_b64_tr_b16 v[154:155], v20 offset:25344
    v_mfma_f32_32x32x16_bf16 v[96:111], v[124:127], v[112:115], v[96:111]
    ds_read_b64_tr_b16 v[156:157], v21 offset:24576
    ds_read_b64_tr_b16 v[158:159], v21 offset:25344
    s_waitcnt lgkmcnt(7)
    v_mfma_f32_32x32x16_bf16 v[64:79], v[132:135], v[128:131], v[64:79]
    ds_read_b128 v[112:115], v22 offset:9216
    ds_read_b64_tr_b16 v[116:117], v19 offset:27648
    ds_read_b64_tr_b16 v[118:119], v19 offset:28416
    v_mfma_f32_32x32x16_bf16 v[80:95], v[136:139], v[128:131], v[80:95]
    ds_read_b64_tr_b16 v[120:121], v20 offset:27648
    ds_read_b64_tr_b16 v[122:123], v20 offset:28416
    v_mfma_f32_32x32x16_bf16 v[96:111], v[140:143], v[128:131], v[96:111]
    ds_read_b64_tr_b16 v[124:125], v21 offset:27648
    ds_read_b64_tr_b16 v[126:127], v21 offset:28416
    s_barrier
    s_waitcnt lgkmcnt(7)
    v_mfma_f32_32x32x16_bf16 v[64:79], v[148:151], v[144:147], v[64:79]
    ds_read_b128 v[128:131], v22 offset:16384
    ds_read_b64_tr_b16 v[132:133], v19 offset:36864
    ds_read_b64_tr_b16 v[134:135], v19 offset:37632
    v_mfma_f32_32x32x16_bf16 v[80:95], v[152:155], v[144:147], v[80:95]
    ds_read_b64_tr_b16 v[136:137], v20 offset:36864
    ds_read_b64_tr_b16 v[138:139], v20 offset:37632
    v_mfma_f32_32x32x16_bf16 v[96:111], v[156:159], v[144:147], v[96:111]
    ds_read_b64_tr_b16 v[140:141], v21 offset:36864
    ds_read_b64_tr_b16 v[142:143], v21 offset:37632
    s_waitcnt lgkmcnt(7)
    v_mfma_f32_32x32x16_bf16 v[64:79], v[116:119], v[112:115], v[64:79]
    ds_read_b128 v[144:147], v22 offset:17408
    ds_read_b64_tr_b16 v[148:149], v19 offset:39936
    ds_read_b64_tr_b16 v[150:151], v19 offset:40704
    v_mfma_f32_32x32x16_bf16 v[80:95], v[120:123], v[112:115], v[80:95]
    ds_read_b64_tr_b16 v[152:153], v20 offset:39936
    ds_read_b64_tr_b16 v[154:155], v20 offset:40704
    v_mfma_f32_32x32x16_bf16 v[96:111], v[124:127], v[112:115], v[96:111]
    ds_read_b64_tr_b16 v[156:157], v21 offset:39936
    ds_read_b64_tr_b16 v[158:159], v21 offset:40704
    s_barrier
    s_waitcnt lgkmcnt(7)
    v_mfma_f32_32x32x16_bf16 v[64:79], v[132:135], v[128:131], v[64:79]
    ds_read_b128 v[112:115], v22 offset:24576
    ds_read_b64_tr_b16 v[116:117], v16 offset:0
    ds_read_b64_tr_b16 v[118:119], v16 offset:768
    v_mfma_f32_32x32x16_bf16 v[80:95], v[136:139], v[128:131], v[80:95]
    ds_read_b64_tr_b16 v[120:121], v17 offset:0
    ds_read_b64_tr_b16 v[122:123], v17 offset:768
    v_mfma_f32_32x32x16_bf16 v[96:111], v[140:143], v[128:131], v[96:111]
    ds_read_b64_tr_b16 v[124:125], v18 offset:0
    ds_read_b64_tr_b16 v[126:127], v18 offset:768
    s_waitcnt lgkmcnt(7)
    v_mfma_f32_32x32x16_bf16 v[64:79], v[148:151], v[144:147], v[64:79]
    ds_read_b128 v[128:131], v22 offset:25600
    ds_read_b64_tr_b16 v[132:133], v16 offset:3072
    ds_read_b64_tr_b16 v[134:135], v16 offset:3840
    v_mfma_f32_32x32x16_bf16 v[80:95], v[152:155], v[144:147], v[80:95]
    ds_read_b64_tr_b16 v[136:137], v17 offset:3072
    ds_read_b64_tr_b16 v[138:139], v17 offset:3840
    v_mfma_f32_32x32x16_bf16 v[96:111], v[156:159], v[144:147], v[96:111]
    ds_read_b64_tr_b16 v[140:141], v18 offset:3072
    ds_read_b64_tr_b16 v[142:143], v18 offset:3840
    s_barrier
    s_waitcnt lgkmcnt(7)
    v_mfma_f32_32x32x16_bf16 v[64:79], v[116:119], v[112:115], v[64:79]
    ds_read_b128 v[144:147], v22 offset:32768
    ds_read_b64_tr_b16 v[148:149], v16 offset:12288
    ds_read_b64_tr_b16 v[150:151], v16 offset:13056
    v_mfma_f32_32x32x16_bf16 v[80:95], v[120:123], v[112:115], v[80:95]
    ds_read_b64_tr_b16 v[152:153], v17 offset:12288
    ds_read_b64_tr_b16 v[154:155], v17 offset:13056
    v_mfma_f32_32x32x16_bf16 v[96:111], v[124:127], v[112:115], v[96:111]
    ds_read_b64_tr_b16 v[156:157], v18 offset:12288
    ds_read_b64_tr_b16 v[158:159], v18 offset:13056
    s_waitcnt lgkmcnt(7)
    v_mfma_f32_32x32x16_bf16 v[64:79], v[132:135], v[128:131], v[64:79]
    ds_read_b128 v[112:115], v22 offset:33792
    ds_read_b64_tr_b16 v[116:117], v16 offset:15360
    ds_read_b64_tr_b16 v[118:119], v16 offset:16128
    v_mfma_f32_32x32x16_bf16 v[80:95], v[136:139], v[128:131], v[80:95]
    ds_read_b64_tr_b16 v[120:121], v17 offset:15360
    ds_read_b64_tr_b16 v[122:123], v17 offset:16128
    v_mfma_f32_32x32x16_bf16 v[96:111], v[140:143], v[128:131], v[96:111]
    ds_read_b64_tr_b16 v[124:125], v18 offset:15360
    ds_read_b64_tr_b16 v[126:127], v18 offset:16128
    s_barrier
    s_waitcnt lgkmcnt(7)
    v_mfma_f32_32x32x16_bf16 v[64:79], v[148:151], v[144:147], v[64:79]
    ds_read_b128 v[128:131], v22 offset:40960
    ds_read_b64_tr_b16 v[132:133], v16 offset:24576
    ds_read_b64_tr_b16 v[134:135], v16 offset:25344
    v_mfma_f32_32x32x16_bf16 v[80:95], v[152:155], v[144:147], v[80:95]
    ds_read_b64_tr_b16 v[136:137], v17 offset:24576
    ds_read_b64_tr_b16 v[138:139], v17 offset:25344
    v_mfma_f32_32x32x16_bf16 v[96:111], v[156:159], v[144:147], v[96:111]
    ds_read_b64_tr_b16 v[140:141], v18 offset:24576
    ds_read_b64_tr_b16 v[142:143], v18 offset:25344
    s_waitcnt lgkmcnt(7)
    v_mfma_f32_32x32x16_bf16 v[64:79], v[116:119], v[112:115], v[64:79]
    ds_read_b128 v[144:147], v22 offset:41984
    ds_read_b64_tr_b16 v[148:149], v16 offset:27648
    ds_read_b64_tr_b16 v[150:151], v16 offset:28416
    v_mfma_f32_32x32x16_bf16 v[80:95], v[120:123], v[112:115], v[80:95]
    ds_read_b64_tr_b16 v[152:153], v17 offset:27648
    ds_read_b64_tr_b16 v[154:155], v17 offset:28416
    v_mfma_f32_32x32x16_bf16 v[96:111], v[124:127], v[112:115], v[96:111]
    ds_read_b64_tr_b16 v[156:157], v18 offset:27648
    ds_read_b64_tr_b16 v[158:159], v18 offset:28416
    s_waitcnt lgkmcnt(7)
    v_mfma_f32_32x32x16_bf16 v[64:79], v[132:135], v[128:131], v[64:79]
    ds_read_b128 v[112:115], v22 offset:0
    ds_read_b64_tr_b16 v[116:117], v16 offset:36864
    ds_read_b64_tr_b16 v[118:119], v16 offset:37632
    v_mfma_f32_32x32x16_bf16 v[80:95], v[136:139], v[128:131], v[80:95]
    ds_read_b64_tr_b16 v[120:121], v17 offset:36864
    ds_read_b64_tr_b16 v[122:123], v17 offset:37632
    v_mfma_f32_32x32x16_bf16 v[96:111], v[140:143], v[128:131], v[96:111]
    ds_read_b64_tr_b16 v[124:125], v18 offset:36864
    ds_read_b64_tr_b16 v[126:127], v18 offset:37632
    s_waitcnt lgkmcnt(7)
    v_mfma_f32_32x32x16_bf16 v[64:79], v[148:151], v[144:147], v[64:79]
    ds_read_b128 v[128:131], v22 offset:1024
    ds_read_b64_tr_b16 v[132:133], v16 offset:39936
    ds_read_b64_tr_b16 v[134:135], v16 offset:40704
    v_mfma_f32_32x32x16_bf16 v[80:95], v[152:155], v[144:147], v[80:95]
    ds_read_b64_tr_b16 v[136:137], v17 offset:39936
    ds_read_b64_tr_b16 v[138:139], v17 offset:40704
    v_mfma_f32_32x32x16_bf16 v[96:111], v[156:159], v[144:147], v[96:111]
    ds_read_b64_tr_b16 v[140:141], v18 offset:39936
    ds_read_b64_tr_b16 v[142:143], v18 offset:40704
    s_waitcnt lgkmcnt(7)
    v_mfma_f32_32x32x16_bf16 v[64:79], v[116:119], v[112:115], v[64:79]
    ds_read_b128 v[144:147], v22 offset:8192
    ds_read_b64_tr_b16 v[148:149], v16 offset:49152
    ds_read_b64_tr_b16 v[150:151], v16 offset:49920
    v_mfma_f32_32x32x16_bf16 v[80:95], v[120:123], v[112:115], v[80:95]
    ds_read_b64_tr_b16 v[152:153], v17 offset:49152
    ds_read_b64_tr_b16 v[154:155], v17 offset:49920
    v_mfma_f32_32x32x16_bf16 v[96:111], v[124:127], v[112:115], v[96:111]
    ds_read_b64_tr_b16 v[156:157], v18 offset:49152
    ds_read_b64_tr_b16 v[158:159], v18 offset:49920
    s_waitcnt lgkmcnt(7)
    v_mfma_f32_32x32x16_bf16 v[64:79], v[132:135], v[128:131], v[64:79]
    ds_read_b128 v[112:115], v22 offset:9216
    ds_read_b64_tr_b16 v[116:117], v16 offset:52224
    ds_read_b64_tr_b16 v[118:119], v16 offset:52992
    v_mfma_f32_32x32x16_bf16 v[80:95], v[136:139], v[128:131], v[80:95]
    ds_read_b64_tr_b16 v[120:121], v17 offset:52224
    ds_read_b64_tr_b16 v[122:123], v17 offset:52992
    v_mfma_f32_32x32x16_bf16 v[96:111], v[140:143], v[128:131], v[96:111]
    ds_read_b64_tr_b16 v[124:125], v18 offset:52224
    ds_read_b64_tr_b16 v[126:127], v18 offset:52992
    s_waitcnt lgkmcnt(7)
    v_mfma_f32_32x32x16_bf16 v[64:79], v[148:151], v[144:147], v[64:79]
    v_mfma_f32_32x32x16_bf16 v[80:95], v[152:155], v[144:147], v[80:95]
    v_mfma_f32_32x32x16_bf16 v[96:111], v[156:159], v[144:147], v[96:111]
    s_waitcnt lgkmcnt(0)
    v_mfma_f32_32x32x16_bf16 v[64:79], v[116:119], v[112:115], v[64:79]
    v_mfma_f32_32x32x16_bf16 v[80:95], v[120:123], v[112:115], v[80:95]
    v_mfma_f32_32x32x16_bf16 v[96:111], v[124:127], v[112:115], v[96:111]
    s_nop 10
    ds_write_b128 v24, v[88:91] offset:0
    ds_write_b128 v24, v[92:95] offset:1024
    ds_write_b128 v24, v[96:99] offset:2048
    ds_write_b128 v24, v[100:103] offset:3072
    ds_write_b128 v24, v[104:107] offset:4096
    ds_write_b128 v24, v[108:111] offset:5120
    s_waitcnt lgkmcnt(0)
    v_mov_b32 v2, 1
    s_mov_b64 exec, 1
    ds_add_u32 v25, v2
    s_mov_b64 exec, -1
    s_mov_b32 s96, 0
Lls_16:
    ds_read_b32 v2, v25
    s_waitcnt lgkmcnt(0)
    v_readfirstlane_b32 s95, v2
    s_nop 0
    s_cmp_ge_u32 s95, 4
    s_cbranch_scc1 Lld_17
    s_add_u32 s96, s96, 1
    s_cmp_lt_u32 s96, 1000000
    s_cbranch_scc1 Lls_16
Lld_17:
    ds_read_b128 v[112:115], v23 offset:0
    ds_read_b128 v[116:119], v23 offset:1024
    ds_read_b128 v[120:123], v23 offset:2048
    ds_read_b128 v[124:127], v23 offset:3072
    ds_read_b128 v[128:131], v23 offset:4096
    ds_read_b128 v[132:135], v23 offset:5120
    s_waitcnt lgkmcnt(4)
    v_pk_add_f32 v[64:65], v[64:65], v[112:113]
    v_pk_add_f32 v[66:67], v[66:67], v[114:115]
    v_pk_add_f32 v[68:69], v[68:69], v[116:117]
    v_pk_add_f32 v[70:71], v[70:71], v[118:119]
    v_pk_mul_f32 v[136:137], v[64:65], v[64:65]
    v_pk_mul_f32 v[138:139], v[66:67], v[66:67]
    v_pk_mul_f32 v[140:141], v[68:69], v[68:69]
    v_pk_mul_f32 v[142:143], v[70:71], v[70:71]
    v_pk_fma_f32 v[136:137], v[136:137], v[12:13], v[14:15]
    v_pk_fma_f32 v[138:139], v[138:139], v[12:13], v[14:15]
    v_pk_fma_f32 v[140:141], v[140:141], v[12:13], v[14:15]
    v_pk_fma_f32 v[142:143], v[142:143], v[12:13], v[14:15]
    v_pk_mul_f32 v[136:137], v[136:137], v[64:65]
    v_pk_mul_f32 v[138:139], v[138:139], v[66:67]
    v_pk_mul_f32 v[140:141], v[140:141], v[68:69]
    v_pk_mul_f32 v[142:143], v[142:143], v[70:71]
    v_exp_f32 v136, v136
    v_exp_f32 v137, v137
    v_exp_f32 v138, v138
    v_exp_f32 v139, v139
    v_exp_f32 v140, v140
    v_exp_f32 v141, v141
    v_exp_f32 v142, v142
    v_exp_f32 v143, v143
    v_pk_add_f32 v[136:137], v[136:137], v[26:27]
    v_pk_add_f32 v[138:139], v[138:139], v[26:27]
    v_pk_add_f32 v[140:141], v[140:141], v[26:27]
    v_pk_add_f32 v[142:143], v[142:143], v[26:27]
    v_rcp_f32 v136, v136
    v_rcp_f32 v137, v137
    v_rcp_f32 v138, v138
    v_rcp_f32 v139, v139
    v_rcp_f32 v140, v140
    v_rcp_f32 v141, v141
    v_rcp_f32 v142, v142
    v_rcp_f32 v143, v143
    v_pk_mul_f32 v[136:137], v[136:137], v[64:65]
    v_pk_mul_f32 v[138:139], v[138:139], v[66:67]
    v_pk_mul_f32 v[140:141], v[140:141], v[68:69]
    v_pk_mul_f32 v[142:143], v[142:143], v[70:71]
    v_cvt_pk_bf16_f32 v40, v136, v137
    v_cvt_pk_bf16_f32 v41, v138, v139
    v_cvt_pk_bf16_f32 v42, v140, v141
    v_cvt_pk_bf16_f32 v43, v142, v143
    buffer_store_dwordx4 v[40:43], v6, s[44:47], s60 offen offset:0 sc1
    s_waitcnt lgkmcnt(2)
    v_pk_add_f32 v[72:73], v[72:73], v[120:121]
    v_pk_add_f32 v[74:75], v[74:75], v[122:123]
    v_pk_add_f32 v[76:77], v[76:77], v[124:125]
    v_pk_add_f32 v[78:79], v[78:79], v[126:127]
    v_pk_mul_f32 v[144:145], v[72:73], v[72:73]
    v_pk_mul_f32 v[146:147], v[74:75], v[74:75]
    v_pk_mul_f32 v[148:149], v[76:77], v[76:77]
    v_pk_mul_f32 v[150:151], v[78:79], v[78:79]
    v_pk_fma_f32 v[144:145], v[144:145], v[12:13], v[14:15]
    v_pk_fma_f32 v[146:147], v[146:147], v[12:13], v[14:15]
    v_pk_fma_f32 v[148:149], v[148:149], v[12:13], v[14:15]
    v_pk_fma_f32 v[150:151], v[150:151], v[12:13], v[14:15]
    v_pk_mul_f32 v[144:145], v[144:145], v[72:73]
    v_pk_mul_f32 v[146:147], v[146:147], v[74:75]
    v_pk_mul_f32 v[148:149], v[148:149], v[76:77]
    v_pk_mul_f32 v[150:151], v[150:151], v[78:79]
    v_exp_f32 v144, v144
    v_exp_f32 v145, v145
    v_exp_f32 v146, v146
    v_exp_f32 v147, v147
    v_exp_f32 v148, v148
    v_exp_f32 v149, v149
    v_exp_f32 v150, v150
    v_exp_f32 v151, v151
    v_pk_add_f32 v[144:145], v[144:145], v[26:27]
    v_pk_add_f32 v[146:147], v[146:147], v[26:27]
    v_pk_add_f32 v[148:149], v[148:149], v[26:27]
    v_pk_add_f32 v[150:151], v[150:151], v[26:27]
    v_rcp_f32 v144, v144
    v_rcp_f32 v145, v145
    v_rcp_f32 v146, v146
    v_rcp_f32 v147, v147
    v_rcp_f32 v148, v148
    v_rcp_f32 v149, v149
    v_rcp_f32 v150, v150
    v_rcp_f32 v151, v151
    v_pk_mul_f32 v[144:145], v[144:145], v[72:73]
    v_pk_mul_f32 v[146:147], v[146:147], v[74:75]
    v_pk_mul_f32 v[148:149], v[148:149], v[76:77]
    v_pk_mul_f32 v[150:151], v[150:151], v[78:79]
    v_cvt_pk_bf16_f32 v44, v144, v145
    v_cvt_pk_bf16_f32 v45, v146, v147
    v_cvt_pk_bf16_f32 v46, v148, v149
    v_cvt_pk_bf16_f32 v47, v150, v151
    buffer_store_dwordx4 v[44:47], v6, s[44:47], s60 offen offset:1024 sc1
    s_waitcnt lgkmcnt(0)
    v_pk_add_f32 v[80:81], v[80:81], v[128:129]
    v_pk_add_f32 v[82:83], v[82:83], v[130:131]
    v_pk_add_f32 v[84:85], v[84:85], v[132:133]
    v_pk_add_f32 v[86:87], v[86:87], v[134:135]
    v_pk_mul_f32 v[152:153], v[80:81], v[80:81]
    v_pk_mul_f32 v[154:155], v[82:83], v[82:83]
    v_pk_mul_f32 v[156:157], v[84:85], v[84:85]
    v_pk_mul_f32 v[158:159], v[86:87], v[86:87]
    v_pk_fma_f32 v[152:153], v[152:153], v[12:13], v[14:15]
    v_pk_fma_f32 v[154:155], v[154:155], v[12:13], v[14:15]
    v_pk_fma_f32 v[156:157], v[156:157], v[12:13], v[14:15]
    v_pk_fma_f32 v[158:159], v[158:159], v[12:13], v[14:15]
    v_pk_mul_f32 v[152:153], v[152:153], v[80:81]
    v_pk_mul_f32 v[154:155], v[154:155], v[82:83]
    v_pk_mul_f32 v[156:157], v[156:157], v[84:85]
    v_pk_mul_f32 v[158:159], v[158:159], v[86:87]
    v_exp_f32 v152, v152
    v_exp_f32 v153, v153
    v_exp_f32 v154, v154
    v_exp_f32 v155, v155
    v_exp_f32 v156, v156
    v_exp_f32 v157, v157
    v_exp_f32 v158, v158
    v_exp_f32 v159, v159
    v_pk_add_f32 v[152:153], v[152:153], v[26:27]
    v_pk_add_f32 v[154:155], v[154:155], v[26:27]
    v_pk_add_f32 v[156:157], v[156:157], v[26:27]
    v_pk_add_f32 v[158:159], v[158:159], v[26:27]
    v_rcp_f32 v152, v152
    v_rcp_f32 v153, v153
    v_rcp_f32 v154, v154
    v_rcp_f32 v155, v155
    v_rcp_f32 v156, v156
    v_rcp_f32 v157, v157
    v_rcp_f32 v158, v158
    v_rcp_f32 v159, v159
    v_pk_mul_f32 v[152:153], v[152:153], v[80:81]
    v_pk_mul_f32 v[154:155], v[154:155], v[82:83]
    v_pk_mul_f32 v[156:157], v[156:157], v[84:85]
    v_pk_mul_f32 v[158:159], v[158:159], v[86:87]
    v_cvt_pk_bf16_f32 v48, v152, v153
    v_cvt_pk_bf16_f32 v49, v154, v155
    v_cvt_pk_bf16_f32 v50, v156, v157
    v_cvt_pk_bf16_f32 v51, v158, v159
    buffer_store_dwordx4 v[48:51], v6, s[44:47], s60 offen offset:2048 sc1
    v_mov_b32 v8, s52
    v_mov_b32 v9, s53
    v_mov_b32 v10, 0
    v_mov_b32 v11, 1
    v_mov_b32 v12, 163828
    s_waitcnt vmcnt(0)
    s_mov_b64 exec, 1
    ds_add_rtn_u32 v11, v12, v11
    s_waitcnt lgkmcnt(0)
    v_readfirstlane_b32 s95, v11
    s_nop 0
    s_cmp_lg_u32 s95, 3
    s_cbranch_scc1 Llf_18
    buffer_store_dwordx2 v[8:9], v10, s[44:47], s61 offen sc1
Llf_18:
    s_mov_b64 exec, -1
L_pcons:
    s_waitcnt vmcnt(0)
    s_barrier
    ds_read_b64_tr_b16 v[112:113], v33 offset:32768
    ds_read_b64_tr_b16 v[114:115], v33 offset:33792
    ds_read_b64_tr_b16 v[116:117], v33 offset:34816
    ds_read_b64_tr_b16 v[118:119], v33 offset:35840
    ds_read_b64_tr_b16 v[120:121], v33 offset:40960
    ds_read_b64_tr_b16 v[122:123], v33 offset:41984
    ds_read_b64_tr_b16 v[124:125], v33 offset:43008
    ds_read_b64_tr_b16 v[126:127], v33 offset:44032
    ds_read_b64_tr_b16 v[128:129], v33 offset:49152
    ds_read_b64_tr_b16 v[130:131], v33 offset:50176
    ds_read_b64_tr_b16 v[132:133], v33 offset:51200
    ds_read_b64_tr_b16 v[134:135], v33 offset:52224
    ds_read_b64_tr_b16 v[136:137], v33 offset:57344
    ds_read_b64_tr_b16 v[138:139], v33 offset:58368
    ds_read_b64_tr_b16 v[140:141], v33 offset:59392
    ds_read_b64_tr_b16 v[142:143], v33 offset:60416
    ds_read_b64_tr_b16 v[144:145], v32 offset:16384
    ds_read_b64_tr_b16 v[146:147], v32 offset:17408
    ds_read_b64_tr_b16 v[148:149], v32 offset:18432
    ds_read_b64_tr_b16 v[150:151], v32 offset:19456
    ds_read_b64_tr_b16 v[152:153], v32 offset:24576
    ds_read_b64_tr_b16 v[154:155], v32 offset:25600
    ds_read_b64_tr_b16 v[156:157], v32 offset:26624
    ds_read_b64_tr_b16 v[158:159], v32 offset:27648
    s_waitcnt lgkmcnt(0)
    s_barrier
    ds_read_b64_tr_b16 v[176:177], v32 offset:32768
    ds_read_b64_tr_b16 v[178:179], v32 offset:33792
    ds_read_b64_tr_b16 v[180:181], v32 offset:34816
    ds_read_b64_tr_b16 v[182:183], v32 offset:35840
    ds_read_b64_tr_b16 v[184:185], v32 offset:40960
    ds_read_b64_tr_b16 v[186:187], v32 offset:41984
    ds_read_b64_tr_b16 v[188:189], v32 offset:43008
    ds_read_b64_tr_b16 v[190:191], v32 offset:44032
    ds_read_b64_tr_b16 v[192:193], v32 offset:49152
    ds_read_b64_tr_b16 v[194:195], v32 offset:50176
    ds_read_b64_tr_b16 v[196:197], v32 offset:51200
    ds_read_b64_tr_b16 v[198:199], v32 offset:52224
    ds_read_b64_tr_b16 v[200:201], v32 offset:57344
    ds_read_b64_tr_b16 v[202:203], v32 offset:58368
    ds_read_b64_tr_b16 v[204:205], v32 offset:59392
    ds_read_b64_tr_b16 v[206:207], v32 offset:60416
    ds_read_b64_tr_b16 v[208:209], v33 offset:0
    ds_read_b64_tr_b16 v[210:211], v33 offset:1024
    ds_read_b64_tr_b16 v[212:213], v33 offset:2048
    ds_read_b64_tr_b16 v[214:215], v33 offset:3072
    ds_read_b64_tr_b16 v[216:217], v33 offset:8192
    ds_read_b64_tr_b16 v[218:219], v33 offset:9216
    ds_read_b64_tr_b16 v[220:221], v33 offset:10240
    ds_read_b64_tr_b16 v[222:223], v33 offset:11264
    ds_read_b64_tr_b16 v[224:225], v33 offset:16384
    ds_read_b64_tr_b16 v[226:227], v33 offset:17408
    ds_read_b64_tr_b16 v[228:229], v33 offset:18432
    ds_read_b64_tr_b16 v[230:231], v33 offset:19456
    ds_read_b64_tr_b16 v[232:233], v33 offset:24576
    ds_read_b64_tr_b16 v[234:235], v33 offset:25600
    ds_read_b64_tr_b16 v[236:237], v33 offset:26624
    ds_read_b64_tr_b16 v[238:239], v33 offset:27648
    s_waitcnt lgkmcnt(0)
    s_barrier
    ds_read_b64_tr_b16 v[160:161], v32 offset:0
    ds_read_b64_tr_b16 v[162:163], v32 offset:1024
    ds_read_b64_tr_b16 v[164:165], v32 offset:2048
    ds_read_b64_tr_b16 v[166:167], v32 offset:3072
    ds_read_b64_tr_b16 v[168:169], v32 offset:8192
    ds_read_b64_tr_b16 v[170:171], v32 offset:9216
    ds_read_b64_tr_b16 v[172:173], v32 offset:10240
    ds_read_b64_tr_b16 v[174:175], v32 offset:11264
    s_waitcnt lgkmcnt(0)
    ds_read_b64_tr_b16 v[240:241], v33 offset:32768
    ds_read_b64_tr_b16 v[242:243], v33 offset:33792
    ds_read_b64_tr_b16 v[244:245], v33 offset:34816
    ds_read_b64_tr_b16 v[246:247], v33 offset:35840
    ds_read_b64_tr_b16 v[248:249], v33 offset:40960
    ds_read_b64_tr_b16 v[250:251], v33 offset:41984
    ds_read_b64_tr_b16 v[252:253], v33 offset:43008
    ds_read_b64_tr_b16 v[254:255], v33 offset:44032
    s_waitcnt lgkmcnt(0)
    s_barrier
    ds_read_b128 v[8:11], v59 offset:49152
    ds_read_b128 v[12:15], v59 offset:53248
    ds_read_b128 v[40:43], v59 offset:50176
    ds_read_b128 v[44:47], v59 offset:54272
    ds_read_b128 v[96:99], v59 offset:57344
    ds_read_b128 v[100:103], v59 offset:61440
    s_waitcnt lgkmcnt(4)
    v_mfma_f32_32x32x16_bf16 v[64:79], v[8:11], v[112:115], 0
    v_mfma_f32_32x32x16_bf16 v[80:95], v[12:15], v[112:115], 0
    ds_read_b128 v[8:11], v59 offset:58368
    ds_read_b128 v[12:15], v59 offset:62464
    s_waitcnt lgkmcnt(4)
    v_mfma_f32_32x32x16_bf16 v[64:79], v[40:43], v[116:119], v[64:79]
    v_mfma_f32_32x32x16_bf16 v[80:95], v[44:47], v[116:119], v[80:95]
    s_barrier
    ds_read_b128 v[40:43], v58 offset:16384
    ds_read_b128 v[44:47], v58 offset:20480
    s_waitcnt lgkmcnt(4)
    v_mfma_f32_32x32x16_bf16 v[64:79], v[96:99], v[120:123], v[64:79]
    v_mfma_f32_32x32x16_bf16 v[80:95], v[100:103], v[120:123], v[80:95]
    ds_read_b128 v[96:99], v58 offset:17408
    ds_read_b128 v[100:103], v58 offset:21504
    s_waitcnt lgkmcnt(4)
    v_mfma_f32_32x32x16_bf16 v[64:79], v[8:11], v[124:127], v[64:79]
    v_mfma_f32_32x32x16_bf16 v[80:95], v[12:15], v[124:127], v[80:95]
    ds_read_b128 v[8:11], v58 offset:24576
    ds_read_b128 v[12:15], v58 offset:28672
    s_waitcnt lgkmcnt(4)
    v_mfma_f32_32x32x16_bf16 v[64:79], v[40:43], v[128:131], v[64:79]
    v_mfma_f32_32x32x16_bf16 v[80:95], v[44:47], v[128:131], v[80:95]
    ds_read_b128 v[40:43], v58 offset:25600
    ds_read_b128 v[44:47], v58 offset:29696
    s_waitcnt lgkmcnt(4)
    v_mfma_f32_32x32x16_bf16 v[64:79], v[96:99], v[132:135], v[64:79]
    v_mfma_f32_32x32x16_bf16 v[80:95], v[100:103], v[132:135], v[80:95]
    s_barrier
    ds_read_b128 v[96:99], v58 offset:32768
    ds_read_b128 v[100:103], v58 offset:36864
    s_waitcnt lgkmcnt(4)
    v_mfma_f32_32x32x16_bf16 v[64:79], v[8:11], v[136:139], v[64:79]
    v_mfma_f32_32x32x16_bf16 v[80:95], v[12:15], v[136:139], v[80:95]
    ds_read_b128 v[8:11], v58 offset:33792
    ds_read_b128 v[12:15], v58 offset:37888
    s_waitcnt lgkmcnt(4)
    v_mfma_f32_32x32x16_bf16 v[64:79], v[40:43], v[140:143], v[64:79]
    v_mfma_f32_32x32x16_bf16 v[80:95], v[44:47], v[140:143], v[80:95]
    ds_read_b128 v[40:43], v58 offset:40960
    ds_read_b128 v[44:47], v58 offset:45056
    s_waitcnt lgkmcnt(4)
    v_mfma_f32_32x32x16_bf16 v[64:79], v[96:99], v[144:147], v[64:79]
    v_mfma_f32_32x32x16_bf16 v[80:95], v[100:103], v[144:147], v[80:95]
    ds_read_b128 v[96:99], v58 offset:41984
    ds_read_b128 v[100:103], v58 offset:46080
    s_waitcnt lgkmcnt(4)
    v_mfma_f32_32x32x16_bf16 v[64:79], v[8:11], v[148:151], v[64:79]
    v_mfma_f32_32x32x16_bf16 v[80:95], v[12:15], v[148:151], v[80:95]
    s_barrier
    ds_read_b128 v[8:11], v58 offset:49152
    ds_read_b128 v[12:15], v58 offset:53248
    s_waitcnt lgkmcnt(4)
    v_mfma_f32_32x32x16_bf16 v[64:79], v[40:43], v[152:155], v[64:79]
    v_mfma_f32_32x32x16_bf16 v[80:95], v[44:47], v[152:155], v[80:95]
    ds_read_b128 v[40:43], v58 offset:50176
    ds_read_b128 v[44:47], v58 offset:54272
    s_waitcnt lgkmcnt(4)
    v_mfma_f32_32x32x16_bf16 v[64:79], v[96:99], v[156:159], v[64:79]
    v_mfma_f32_32x32x16_bf16 v[80:95], v[100:103], v[156:159], v[80:95]
    ds_read_b128 v[96:99], v58 offset:57344
    ds_read_b128 v[100:103], v58 offset:61440
    s_waitcnt lgkmcnt(4)
    v_mfma_f32_32x32x16_bf16 v[64:79], v[8:11], v[160:163], v[64:79]
    v_mfma_f32_32x32x16_bf16 v[80:95], v[12:15], v[160:163], v[80:95]
    ds_read_b128 v[8:11], v58 offset:58368
    ds_read_b128 v[12:15], v58 offset:62464
    s_waitcnt lgkmcnt(4)
    v_mfma_f32_32x32x16_bf16 v[64:79], v[40:43], v[164:167], v[64:79]
    v_mfma_f32_32x32x16_bf16 v[80:95], v[44:47], v[164:167], v[80:95]
    s_barrier
    ds_read_b128 v[40:43], v59 offset:0
    ds_read_b128 v[44:47], v59 offset:4096
    s_waitcnt lgkmcnt(4)
    v_mfma_f32_32x32x16_bf16 v[64:79], v[96:99], v[168:171], v[64:79]
    v_mfma_f32_32x32x16_bf16 v[80:95], v[100:103], v[168:171], v[80:95]
    ds_read_b128 v[96:99], v59 offset:1024
    ds_read_b128 v[100:103], v59 offset:5120
    s_waitcnt lgkmcnt(4)
    v_mfma_f32_32x32x16_bf16 v[64:79], v[8:11], v[172:175], v[64:79]
    v_mfma_f32_32x32x16_bf16 v[80:95], v[12:15], v[172:175], v[80:95]
    ds_read_b128 v[8:11], v59 offset:8192
    ds_read_b128 v[12:15], v59 offset:12288
    s_waitcnt lgkmcnt(4)
    v_mfma_f32_32x32x16_bf16 v[64:79], v[40:43], v[176:179], v[64:79]
    v_mfma_f32_32x32x16_bf16 v[80:95], v[44:47], v[176:179], v[80:95]
    ds_read_b128 v[40:43], v59 offset:9216
    ds_read_b128 v[44:47], v59 offset:13312
    s_waitcnt lgkmcnt(4)
    v_mfma_f32_32x32x16_bf16 v[64:79], v[96:99], v[180:183], v[64:79]
    v_mfma_f32_32x32x16_bf16 v[80:95], v[100:103], v[180:183], v[80:95]
    ds_read_b128 v[96:99], v59 offset:16384
    ds_read_b128 v[100:103], v59 offset:20480
    s_waitcnt lgkmcnt(4)
    v_mfma_f32_32x32x16_bf16 v[64:79], v[8:11], v[184:187], v[64:79]
    v_mfma_f32_32x32x16_bf16 v[80:95], v[12:15], v[184:187], v[80:95]
    ds_read_b128 v[8:11], v59 offset:17408
    ds_read_b128 v[12:15], v59 offset:21504
    s_waitcnt lgkmcnt(4)
    v_mfma_f32_32x32x16_bf16 v[64:79], v[40:43], v[188:191], v[64:79]
    v_mfma_f32_32x32x16_bf16 v[80:95], v[44:47], v[188:191], v[80:95]
    s_barrier
    ds_read_b128 v[40:43], v59 offset:24576
    ds_read_b128 v[44:47], v59 offset:28672
    s_waitcnt lgkmcnt(4)
    v_mfma_f32_32x32x16_bf16 v[64:79], v[96:99], v[192:195], v[64:79]
    v_mfma_f32_32x32x16_bf16 v[80:95], v[100:103], v[192:195], v[80:95]
    ds_read_b128 v[96:99], v59 offset:25600
    ds_read_b128 v[100:103], v59 offset:29696
    s_waitcnt lgkmcnt(4)
    v_mfma_f32_32x32x16_bf16 v[64:79], v[8:11], v[196:199], v[64:79]
    v_mfma_f32_32x32x16_bf16 v[80:95], v[12:15], v[196:199], v[80:95]
    ds_read_b128 v[8:11], v59 offset:32768
    ds_read_b128 v[12:15], v59 offset:36864
    s_waitcnt lgkmcnt(4)
    v_mfma_f32_32x32x16_bf16 v[64:79], v[40:43], v[200:203], v[64:79]
    v_mfma_f32_32x32x16_bf16 v[80:95], v[44:47], v[200:203], v[80:95]
    ds_read_b128 v[40:43], v59 offset:33792
    ds_read_b128 v[44:47], v59 offset:37888
    s_waitcnt lgkmcnt(4)
    v_mfma_f32_32x32x16_bf16 v[64:79], v[96:99], v[204:207], v[64:79]
    v_mfma_f32_32x32x16_bf16 v[80:95], v[100:103], v[204:207], v[80:95]
    ds_read_b128 v[96:99], v59 offset:40960
    ds_read_b128 v[100:103], v59 offset:45056
    s_waitcnt lgkmcnt(4)
    v_mfma_f32_32x32x16_bf16 v[64:79], v[8:11], v[208:211], v[64:79]
    v_mfma_f32_32x32x16_bf16 v[80:95], v[12:15], v[208:211], v[80:95]
    ds_read_b128 v[8:11], v59 offset:41984
    ds_read_b128 v[12:15], v59 offset:46080
    s_waitcnt lgkmcnt(4)
    v_mfma_f32_32x32x16_bf16 v[64:79], v[40:43], v[212:215], v[64:79]
    v_mfma_f32_32x32x16_bf16 v[80:95], v[44:47], v[212:215], v[80:95]
    s_barrier
    ds_read_b128 v[40:43], v58 offset:0
    ds_read_b128 v[44:47], v58 offset:4096
    s_waitcnt lgkmcnt(4)
    v_mfma_f32_32x32x16_bf16 v[64:79], v[96:99], v[216:219], v[64:79]
    v_mfma_f32_32x32x16_bf16 v[80:95], v[100:103], v[216:219], v[80:95]
    ds_read_b128 v[96:99], v58 offset:1024
    ds_read_b128 v[100:103], v58 offset:5120
    s_waitcnt lgkmcnt(4)
    v_mfma_f32_32x32x16_bf16 v[64:79], v[8:11], v[220:223], v[64:79]
    v_mfma_f32_32x32x16_bf16 v[80:95], v[12:15], v[220:223], v[80:95]
    ds_read_b128 v[8:11], v58 offset:8192
    ds_read_b128 v[12:15], v58 offset:12288
    s_waitcnt lgkmcnt(4)
    v_mfma_f32_32x32x16_bf16 v[64:79], v[40:43], v[224:227], v[64:79]
    v_mfma_f32_32x32x16_bf16 v[80:95], v[44:47], v[224:227], v[80:95]
    ds_read_b128 v[40:43], v58 offset:9216
    ds_read_b128 v[44:47], v58 offset:13312
    s_waitcnt lgkmcnt(4)
    v_mfma_f32_32x32x16_bf16 v[64:79], v[96:99], v[228:231], v[64:79]
    v_mfma_f32_32x32x16_bf16 v[80:95], v[100:103], v[228:231], v[80:95]
    ds_read_b128 v[96:99], v59 offset:49152
    ds_read_b128 v[100:103], v59 offset:53248
    s_waitcnt lgkmcnt(4)
    v_mfma_f32_32x32x16_bf16 v[64:79], v[8:11], v[232:235], v[64:79]
    v_mfma_f32_32x32x16_bf16 v[80:95], v[12:15], v[232:235], v[80:95]
    ds_read_b128 v[8:11], v59 offset:50176
    ds_read_b128 v[12:15], v59 offset:54272
    s_waitcnt lgkmcnt(4)
    v_mfma_f32_32x32x16_bf16 v[64:79], v[40:43], v[236:239], v[64:79]
    v_mfma_f32_32x32x16_bf16 v[80:95], v[44:47], v[236:239], v[80:95]
    s_barrier
    ds_read_b128 v[40:43], v59 offset:57344
    ds_read_b128 v[44:47], v59 offset:61440
    s_waitcnt lgkmcnt(4)
    v_mfma_f32_32x32x16_bf16 v[64:79], v[96:99], v[240:243], v[64:79]
    v_mfma_f32_32x32x16_bf16 v[80:95], v[100:103], v[240:243], v[80:95]
    ds_read_b128 v[96:99], v59 offset:58368
    ds_read_b128 v[100:103], v59 offset:62464
    s_waitcnt lgkmcnt(4)
    v_mfma_f32_32x32x16_bf16 v[64:79], v[8:11], v[244:247], v[64:79]
    v_mfma_f32_32x32x16_bf16 v[80:95], v[12:15], v[244:247], v[80:95]
    ds_read_b128 v[8:11], v58 offset:16384
    ds_read_b128 v[12:15], v58 offset:20480
    ds_read_b64_tr_b16 v[16:17], v34 offset:0
    ds_read_b64_tr_b16 v[18:19], v34 offset:1024
    s_waitcnt lgkmcnt(6)
    v_mfma_f32_32x32x16_bf16 v[64:79], v[40:43], v[248:251], v[64:79]
    v_mfma_f32_32x32x16_bf16 v[80:95], v[44:47], v[248:251], v[80:95]
    ds_read_b128 v[40:43], v58 offset:17408
    ds_read_b128 v[44:47], v58 offset:21504
    ds_read_b64_tr_b16 v[48:49], v34 offset:2048
    ds_read_b64_tr_b16 v[50:51], v34 offset:3072
    s_waitcnt lgkmcnt(8)
    v_mfma_f32_32x32x16_bf16 v[64:79], v[96:99], v[252:255], v[64:79]
    v_mfma_f32_32x32x16_bf16 v[80:95], v[100:103], v[252:255], v[80:95]
    ds_read_b128 v[96:99], v58 offset:24576
    ds_read_b128 v[100:103], v58 offset:28672
    ds_read_b64_tr_b16 v[104:105], v34 offset:8192
    ds_read_b64_tr_b16 v[106:107], v34 offset:9216
    s_waitcnt lgkmcnt(8)
    v_mfma_f32_32x32x16_bf16 v[64:79], v[8:11], v[16:19], v[64:79]
    v_mfma_f32_32x32x16_bf16 v[80:95], v[12:15], v[16:19], v[80:95]
    ds_read_b128 v[8:11], v58 offset:25600
    ds_read_b128 v[12:15], v58 offset:29696
    ds_read_b64_tr_b16 v[16:17], v34 offset:10240
    ds_read_b64_tr_b16 v[18:19], v34 offset:11264
    s_waitcnt lgkmcnt(8)
    v_mfma_f32_32x32x16_bf16 v[64:79], v[40:43], v[48:51], v[64:79]
    v_mfma_f32_32x32x16_bf16 v[80:95], v[44:47], v[48:51], v[80:95]
    s_barrier
    ds_read_b128 v[40:43], v58 offset:32768
    ds_read_b128 v[44:47], v58 offset:36864
    ds_read_b64_tr_b16 v[48:49], v34 offset:16384
    ds_read_b64_tr_b16 v[50:51], v34 offset:17408
    s_waitcnt lgkmcnt(8)
    v_mfma_f32_32x32x16_bf16 v[64:79], v[96:99], v[104:107], v[64:79]
    v_mfma_f32_32x32x16_bf16 v[80:95], v[100:103], v[104:107], v[80:95]
    ds_read_b128 v[96:99], v58 offset:33792
    ds_read_b128 v[100:103], v58 offset:37888
    ds_read_b64_tr_b16 v[104:105], v34 offset:18432
    ds_read_b64_tr_b16 v[106:107], v34 offset:19456
    s_waitcnt lgkmcnt(8)
    v_mfma_f32_32x32x16_bf16 v[64:79], v[8:11], v[16:19], v[64:79]
    v_mfma_f32_32x32x16_bf16 v[80:95], v[12:15], v[16:19], v[80:95]
    ds_read_b128 v[8:11], v58 offset:40960
    ds_read_b128 v[12:15], v58 offset:45056
    ds_read_b64_tr_b16 v[16:17], v34 offset:24576
    ds_read_b64_tr_b16 v[18:19], v34 offset:25600
    s_waitcnt lgkmcnt(8)
    v_mfma_f32_32x32x16_bf16 v[64:79], v[40:43], v[48:51], v[64:79]
    v_mfma_f32_32x32x16_bf16 v[80:95], v[44:47], v[48:51], v[80:95]
    ds_read_b128 v[40:43], v58 offset:41984
    ds_read_b128 v[44:47], v58 offset:46080
    ds_read_b64_tr_b16 v[48:49], v34 offset:26624
    ds_read_b64_tr_b16 v[50:51], v34 offset:27648
    s_waitcnt lgkmcnt(8)
    v_mfma_f32_32x32x16_bf16 v[64:79], v[96:99], v[104:107], v[64:79]
    v_mfma_f32_32x32x16_bf16 v[80:95], v[100:103], v[104:107], v[80:95]
    s_waitcnt lgkmcnt(4)
    v_mfma_f32_32x32x16_bf16 v[64:79], v[8:11], v[16:19], v[64:79]
    v_mfma_f32_32x32x16_bf16 v[80:95], v[12:15], v[16:19], v[80:95]
    s_waitcnt lgkmcnt(0)
    v_mfma_f32_32x32x16_bf16 v[64:79], v[40:43], v[48:51], v[64:79]
    v_mfma_f32_32x32x16_bf16 v[80:95], v[44:47], v[48:51], v[80:95]
    s_nop 10
    ds_write_b128 v54, v[64:67] offset:49152
    ds_write_b128 v54, v[68:71] offset:49184
    ds_write_b128 v54, v[72:75] offset:49216
    ds_write_b128 v54, v[76:79] offset:49248
    ds_write_b128 v54, v[80:83] offset:49280
    ds_write_b128 v54, v[84:87] offset:49312
    ds_write_b128 v54, v[88:91] offset:49344
    ds_write_b128 v54, v[92:95] offset:49376
    s_branch L_fin
L_pload:
    v_mov_b32 v11, 163808
    s_waitcnt vmcnt(10)
    v_mov_b32 v10, 1
    s_mov_b64 exec, 1
    ds_add_u32 v11, v10
    s_mov_b64 exec, -1
    s_mov_b32 s96, 0
Lls_19:
    ds_read_b32 v10, v11
    s_waitcnt lgkmcnt(0)
    v_readfirstlane_b32 s95, v10
    s_nop 0
    s_cmp_ge_u32 s95, 4
    s_cbranch_scc1 Lld_20
    s_add_u32 s96, s96, 1
    s_cmp_lt_u32 s96, 1000000
    s_cbranch_scc1 Lls_19
Lld_20:
    ds_read_b64_tr_b16 v[128:129], v28 offset:32768
    ds_read_b64_tr_b16 v[130:131], v28 offset:33792
    ds_read_b64_tr_b16 v[132:133], v29 offset:32768
    ds_read_b64_tr_b16 v[134:135], v29 offset:33792
    ds_read_b64_tr_b16 v[136:137], v28 offset:34816
    ds_read_b64_tr_b16 v[138:139], v28 offset:35840
    ds_read_b64_tr_b16 v[140:141], v29 offset:34816
    ds_read_b64_tr_b16 v[142:143], v29 offset:35840
    ds_read_b64_tr_b16 v[144:145], v28 offset:40960
    ds_read_b64_tr_b16 v[146:147], v28 offset:41984
    ds_read_b64_tr_b16 v[148:149], v29 offset:40960
    ds_read_b64_tr_b16 v[150:151], v29 offset:41984
    ds_read_b64_tr_b16 v[152:153], v28 offset:43008
    ds_read_b64_tr_b16 v[154:155], v28 offset:44032
    ds_read_b64_tr_b16 v[156:157], v29 offset:43008
    ds_read_b64_tr_b16 v[158:159], v29 offset:44032
    ds_read_b64_tr_b16 v[160:161], v28 offset:49152
    ds_read_b64_tr_b16 v[162:163], v28 offset:50176
    ds_read_b64_tr_b16 v[164:165], v29 offset:49152
    ds_read_b64_tr_b16 v[166:167], v29 offset:50176
    ds_read_b64_tr_b16 v[168:169], v28 offset:51200
    ds_read_b64_tr_b16 v[170:171], v28 offset:52224
    ds_read_b64_tr_b16 v[172:173], v29 offset:51200
    ds_read_b64_tr_b16 v[174:175], v29 offset:52224
    ds_read_b64_tr_b16 v[176:177], v28 offset:57344
    ds_read_b64_tr_b16 v[178:179], v28 offset:58368
    ds_read_b64_tr_b16 v[180:181], v29 offset:57344
    ds_read_b64_tr_b16 v[182:183], v29 offset:58368
    ds_read_b64_tr_b16 v[184:185], v28 offset:59392
    ds_read_b64_tr_b16 v[186:187], v28 offset:60416
    ds_read_b64_tr_b16 v[188:189], v29 offset:59392
    ds_read_b64_tr_b16 v[190:191], v29 offset:60416
    ds_read_b64_tr_b16 v[192:193], v30 offset:0
    ds_read_b64_tr_b16 v[194:195], v30 offset:1024
    ds_read_b64_tr_b16 v[196:197], v31 offset:0
    ds_read_b64_tr_b16 v[198:199], v31 offset:1024
    ds_read_b64_tr_b16 v[200:201], v30 offset:2048
    ds_read_b64_tr_b16 v[202:203], v30 offset:3072
    ds_read_b64_tr_b16 v[204:205], v31 offset:2048
    ds_read_b64_tr_b16 v[206:207], v31 offset:3072
    ds_read_b64_tr_b16 v[208:209], v30 offset:8192
    ds_read_b64_tr_b16 v[210:211], v30 offset:9216
    ds_read_b64_tr_b16 v[212:213], v31 offset:8192
    ds_read_b64_tr_b16 v[214:215], v31 offset:9216
    ds_read_b64_tr_b16 v[216:217], v30 offset:10240
    ds_read_b64_tr_b16 v[218:219], v30 offset:11264
    ds_read_b64_tr_b16 v[220:221], v31 offset:10240
    ds_read_b64_tr_b16 v[222:223], v31 offset:11264
    ds_read_b64_tr_b16 v[224:225], v30 offset:16384
    ds_read_b64_tr_b16 v[226:227], v30 offset:17408
    ds_read_b64_tr_b16 v[228:229], v31 offset:16384
    ds_read_b64_tr_b16 v[230:231], v31 offset:17408
    ds_read_b64_tr_b16 v[232:233], v30 offset:18432
    ds_read_b64_tr_b16 v[234:235], v30 offset:19456
    ds_read_b64_tr_b16 v[236:237], v31 offset:18432
    ds_read_b64_tr_b16 v[238:239], v31 offset:19456
    ds_read_b64_tr_b16 v[240:241], v30 offset:24576
    ds_read_b64_tr_b16 v[242:243], v30 offset:25600
    ds_read_b64_tr_b16 v[244:245], v31 offset:24576
    ds_read_b64_tr_b16 v[246:247], v31 offset:25600
    ds_read_b64_tr_b16 v[248:249], v30 offset:26624
    ds_read_b64_tr_b16 v[250:251], v30 offset:27648
    ds_read_b64_tr_b16 v[252:253], v31 offset:26624
    ds_read_b64_tr_b16 v[254:255], v31 offset:27648
    s_waitcnt lgkmcnt(0)
    v_mov_b32 v10, 1
    s_mov_b64 exec, 1
    ds_add_u32 v11, v10
    s_mov_b64 exec, -1
    s_mov_b32 s96, 0
Lls_21:
    ds_read_b32 v10, v11
    s_waitcnt lgkmcnt(0)
    v_readfirstlane_b32 s95, v10
    s_nop 0
    s_cmp_ge_u32 s95, 8
    s_cbranch_scc1 Lld_22
    s_add_u32 s96, s96, 1
    s_cmp_lt_u32 s96, 1000000
    s_cbranch_scc1 Lls_21
Lld_22:
    s_add_u32 s68, s3, 8
    s_cmp_ge_u32 s68, 22
    s_cselect_b32 s54, 22, 0
    s_sub_u32 s68, s68, s54
    s_lshl_b32 s68, s68, 18
    s_add_u32 m0, s69, 32768
    s_nop 0
    buffer_load_dwordx4 v60, s[28:31], s68 offen lds
    s_add_u32 m0, s69, 33792
    s_nop 0
    buffer_load_dwordx4 v61, s[28:31], s68 offen lds
    s_add_u32 s68, s3, 9
    s_cmp_ge_u32 s68, 22
    s_cselect_b32 s54, 22, 0
    s_sub_u32 s68, s68, s54
    s_lshl_b32 s68, s68, 18
    s_add_u32 m0, s69, 40960
    s_nop 0
    buffer_load_dwordx4 v60, s[28:31], s68 offen lds
    s_add_u32 m0, s69, 41984
    s_nop 0
    buffer_load_dwordx4 v61, s[28:31], s68 offen lds
    s_add_u32 s68, s3, 10
    s_cmp_ge_u32 s68, 22
    s_cselect_b32 s54, 22, 0
    s_sub_u32 s68, s68, s54
    s_lshl_b32 s68, s68, 18
    s_add_u32 m0, s69, 49152
    s_nop 0
    buffer_load_dwordx4 v60, s[28:31], s68 offen lds
    s_add_u32 m0, s69, 50176
    s_nop 0
    buffer_load_dwordx4 v61, s[28:31], s68 offen lds
    s_add_u32 s68, s3, 11
    s_cmp_ge_u32 s68, 22
    s_cselect_b32 s54, 22, 0
    s_sub_u32 s68, s68, s54
    s_lshl_b32 s68, s68, 18
    s_add_u32 m0, s69, 57344
    s_nop 0
    buffer_load_dwordx4 v60, s[28:31], s68 offen lds
    s_add_u32 m0, s69, 58368
    s_nop 0
    buffer_load_dwordx4 v61, s[28:31], s68 offen lds
    buffer_load_dwordx2 v[8:9], v59, s[44:47], 0 offen sc1
    s_add_u32 s68, s3, 12
    s_cmp_ge_u32 s68, 22
    s_cselect_b32 s54, 22, 0
    s_sub_u32 s68, s68, s54
    s_lshl_b32 s68, s68, 18
    s_add_u32 m0, s69, 65536
    s_nop 0
    buffer_load_dwordx4 v60, s[28:31], s68 offen lds
    s_add_u32 m0, s69, 66560
    s_nop 0
    buffer_load_dwordx4 v61, s[28:31], s68 offen lds
    s_add_u32 s68, s3, 13
    s_cmp_ge_u32 s68, 22
    s_cselect_b32 s54, 22, 0
    s_sub_u32 s68, s68, s54
    s_lshl_b32 s68, s68, 18
    s_add_u32 m0, s69, 73728
    s_nop 0
    buffer_load_dwordx4 v60, s[28:31], s68 offen lds
    s_add_u32 m0, s69, 74752
    s_nop 0
    buffer_load_dwordx4 v61, s[28:31], s68 offen lds
    s_add_u32 s68, s3, 14
    s_cmp_ge_u32 s68, 22
    s_cselect_b32 s54, 22, 0
    s_sub_u32 s68, s68, s54
    s_lshl_b32 s68, s68, 18
    s_add_u32 m0, s69, 81920
    s_nop 0
    buffer_load_dwordx4 v60, s[28:31], s68 offen lds
    s_add_u32 m0, s69, 82944
    s_nop 0
    buffer_load_dwordx4 v61, s[28:31], s68 offen lds
    s_add_u32 s68, s3, 15
    s_cmp_ge_u32 s68, 22
    s_cselect_b32 s54, 22, 0
    s_sub_u32 s68, s68, s54
    s_lshl_b32 s68, s68, 18
    s_add_u32 m0, s69, 90112
    s_nop 0
    buffer_load_dwordx4 v60, s[28:31], s68 offen lds
    s_add_u32 m0, s69, 91136
    s_nop 0
    buffer_load_dwordx4 v61, s[28:31], s68 offen lds
    s_waitcnt vmcnt(8)
    v_cmp_ne_u64 vcc, s[52:53], v[8:9]
    s_nop 0
    s_cmp_eq_u64 vcc, 0
    s_cselect_b32 s67, 1, 0
    s_cbranch_scc0 L_po1
    s_add_u32 s65, s97, 0
    s_and_b32 s65, s65, 7
    s_lshl_b32 s65, s65, 12
    s_add_u32 s65, s65, s92
    buffer_load_dwordx4 v[96:99], v6, s[44:47], s65 offen offset:0 sc1
    buffer_load_dwordx4 v[100:103], v6, s[44:47], s65 offen offset:1024 sc1
    s_add_u32 s65, s97, 1
    s_and_b32 s65, s65, 7
    s_lshl_b32 s65, s65, 12
    s_add_u32 s65, s65, s92
    buffer_load_dwordx4 v[104:107], v6, s[44:47], s65 offen offset:0 sc1
    buffer_load_dwordx4 v[108:111], v6, s[44:47], s65 offen offset:1024 sc1
    s_add_u32 s65, s97, 2
    s_and_b32 s65, s65, 7
    s_lshl_b32 s65, s65, 12
    s_add_u32 s65, s65, s92
    buffer_load_dwordx4 v[112:115], v6, s[44:47], s65 offen offset:0 sc1
    buffer_load_dwordx4 v[116:119], v6, s[44:47], s65 offen offset:1024 sc1
    s_add_u32 s65, s97, 3
    s_and_b32 s65, s65, 7
    s_lshl_b32 s65, s65, 12
    s_add_u32 s65, s65, s92
    buffer_load_dwordx4 v[120:123], v6, s[44:47], s65 offen offset:0 sc1
    buffer_load_dwordx4 v[124:127], v6, s[44:47], s65 offen offset:1024 sc1
    s_add_u32 s65, s97, 4
    s_and_b32 s65, s65, 7
    s_lshl_b32 s65, s65, 12
    s_add_u32 s65, s65, s92
    buffer_load_dwordx4 v[12:15], v6, s[44:47], s65 offen offset:0 sc1
    buffer_load_dwordx4 v[16:19], v6, s[44:47], s65 offen offset:1024 sc1
    s_add_u32 s65, s97, 5
    s_and_b32 s65, s65, 7
    s_lshl_b32 s65, s65, 12
    s_add_u32 s65, s65, s92
    buffer_load_dwordx4 v[20:23], v6, s[44:47], s65 offen offset:0 sc1
    buffer_load_dwordx4 v[24:27], v6, s[44:47], s65 offen offset:1024 sc1
    s_add_u32 s65, s97, 6
    s_and_b32 s65, s65, 7
    s_lshl_b32 s65, s65, 12
    s_add_u32 s65, s65, s92
    buffer_load_dwordx4 v[32:35], v6, s[44:47], s65 offen offset:0 sc1
    buffer_load_dwordx4 v[40:43], v6, s[44:47], s65 offen offset:1024 sc1
    s_add_u32 s65, s97, 7
    s_and_b32 s65, s65, 7
    s_lshl_b32 s65, s65, 12
    s_add_u32 s65, s65, s92
    buffer_load_dwordx4 v[44:47], v6, s[44:47], s65 offen offset:0 sc1
    buffer_load_dwordx4 v[48:51], v6, s[44:47], s65 offen offset:1024 sc1
L_po1:
    s_barrier
    buffer_load_dwordx2 v[8:9], v59, s[44:47], 0 offen sc1
    s_add_u32 s68, s3, 6
    s_cmp_ge_u32 s68, 22
    s_cselect_b32 s54, 22, 0
    s_sub_u32 s68, s68, s54
    s_lshl_b32 s68, s68, 18
    s_add_u32 m0, s69, 0
    s_nop 0
    buffer_load_dwordx4 v60, s[28:31], s68 offen lds
    s_add_u32 m0, s69, 1024
    s_nop 0
    buffer_load_dwordx4 v61, s[28:31], s68 offen lds
    s_add_u32 s68, s3, 7
    s_cmp_ge_u32 s68, 22
    s_cselect_b32 s54, 22, 0
    s_sub_u32 s68, s68, s54
    s_lshl_b32 s68, s68, 18
    s_add_u32 m0, s69, 8192
    s_nop 0
    buffer_load_dwordx4 v60, s[28:31], s68 offen lds
    s_add_u32 m0, s69, 9216
    s_nop 0
    buffer_load_dwordx4 v61, s[28:31], s68 offen lds
    s_add_u32 s68, s3, 18
    s_cmp_ge_u32 s68, 22
    s_cselect_b32 s54, 22, 0
    s_sub_u32 s68, s68, s54
    s_lshl_b32 s68, s68, 18
    s_add_u32 m0, s69, 131072
    s_nop 0
    buffer_load_dwordx4 v60, s[28:31], s68 offen lds
    s_add_u32 m0, s69, 132096
    s_nop 0
    buffer_load_dwordx4 v61, s[28:31], s68 offen lds
    s_add_u32 s68, s3, 19
    s_cmp_ge_u32 s68, 22
    s_cselect_b32 s54, 22, 0
    s_sub_u32 s68, s68, s54
    s_lshl_b32 s68, s68, 18
    s_add_u32 m0, s69, 139264
    s_nop 0
    buffer_load_dwordx4 v60, s[28:31], s68 offen lds
    s_add_u32 m0, s69, 140288
    s_nop 0
    buffer_load_dwordx4 v61, s[28:31], s68 offen lds
    s_add_u32 s68, s3, 20
    s_cmp_ge_u32 s68, 22
    s_cselect_b32 s54, 22, 0
    s_sub_u32 s68, s68, s54
    s_lshl_b32 s68, s68, 18
    s_add_u32 m0, s69, 147456
    s_nop 0
    buffer_load_dwordx4 v60, s[28:31], s68 offen lds
    s_add_u32 m0, s69, 148480
    s_nop 0
    buffer_load_dwordx4 v61, s[28:31], s68 offen lds
    s_add_u32 s68, s3, 21
    s_cmp_ge_u32 s68, 22
    s_cselect_b32 s54, 22, 0
    s_sub_u32 s68, s68, s54
    s_lshl_b32 s68, s68, 18
    s_add_u32 m0, s69, 155648
    s_nop 0
    buffer_load_dwordx4 v60, s[28:31], s68 offen lds
    s_add_u32 m0, s69, 156672
    s_nop 0
    buffer_load_dwordx4 v61, s[28:31], s68 offen lds
    s_cmp_eq_u32 s67, 0
    s_cbranch_scc1 L_po2a
    s_waitcnt vmcnt(13)
    v_mfma_f32_32x32x16_bf16 v[64:79], v[128:131], v[96:99], 0
    v_mfma_f32_32x32x16_bf16 v[80:95], v[132:135], v[96:99], 0
    v_mfma_f32_32x32x16_bf16 v[64:79], v[136:139], v[100:103], v[64:79]
    v_mfma_f32_32x32x16_bf16 v[80:95], v[140:143], v[100:103], v[80:95]
    v_mfma_f32_32x32x16_bf16 v[64:79], v[144:147], v[104:107], v[64:79]
    v_mfma_f32_32x32x16_bf16 v[80:95], v[148:151], v[104:107], v[80:95]
    v_mfma_f32_32x32x16_bf16 v[64:79], v[152:155], v[108:111], v[64:79]
    v_mfma_f32_32x32x16_bf16 v[80:95], v[156:159], v[108:111], v[80:95]
    v_mfma_f32_32x32x16_bf16 v[64:79], v[160:163], v[112:115], v[64:79]
    v_mfma_f32_32x32x16_bf16 v[80:95], v[164:167], v[112:115], v[80:95]
    v_mfma_f32_32x32x16_bf16 v[64:79], v[168:171], v[116:119], v[64:79]
    v_mfma_f32_32x32x16_bf16 v[80:95], v[172:175], v[116:119], v[80:95]
    v_mfma_f32_32x32x16_bf16 v[64:79], v[176:179], v[120:123], v[64:79]
    v_mfma_f32_32x32x16_bf16 v[80:95], v[180:183], v[120:123], v[80:95]
    v_mfma_f32_32x32x16_bf16 v[64:79], v[184:187], v[124:127], v[64:79]
    v_mfma_f32_32x32x16_bf16 v[80:95], v[188:191], v[124:127], v[80:95]
    s_branch L_po2
L_po2a:
    s_waitcnt vmcnt(12)
    v_cmp_ne_u64 vcc, s[52:53], v[8:9]
    s_nop 0
    s_cmp_eq_u64 vcc, 0
    s_cselect_b32 s67, 2, 0
    s_cbranch_scc0 L_po2
    s_barrier
    s_add_u32 s65, s97, 0
    s_and_b32 s65, s65, 7
    s_lshl_b32 s65, s65, 12
    s_add_u32 s65, s65, s92
    buffer_load_dwordx4 v[96:99], v6, s[44:47], s65 offen offset:0 sc1
    buffer_load_dwordx4 v[100:103], v6, s[44:47], s65 offen offset:1024 sc1
    s_add_u32 s65, s97, 1
    s_and_b32 s65, s65, 7
    s_lshl_b32 s65, s65, 12
    s_add_u32 s65, s65, s92
    buffer_load_dwordx4 v[104:107], v6, s[44:47], s65 offen offset:0 sc1
    buffer_load_dwordx4 v[108:111], v6, s[44:47], s65 offen offset:1024 sc1
    s_add_u32 s65, s97, 2
    s_and_b32 s65, s65, 7
    s_lshl_b32 s65, s65, 12
    s_add_u32 s65, s65, s92
    buffer_load_dwordx4 v[112:115], v6, s[44:47], s65 offen offset:0 sc1
    buffer_load_dwordx4 v[116:119], v6, s[44:47], s65 offen offset:1024 sc1
    s_add_u32 s65, s97, 3
    s_and_b32 s65, s65, 7
    s_lshl_b32 s65, s65, 12
    s_add_u32 s65, s65, s92
    buffer_load_dwordx4 v[120:123], v6, s[44:47], s65 offen offset:0 sc1
    buffer_load_dwordx4 v[124:127], v6, s[44:47], s65 offen offset:1024 sc1
    s_add_u32 s65, s97, 4
    s_and_b32 s65, s65, 7
    s_lshl_b32 s65, s65, 12
    s_add_u32 s65, s65, s92
    buffer_load_dwordx4 v[12:15], v6, s[44:47], s65 offen offset:0 sc1
    buffer_load_dwordx4 v[16:19], v6, s[44:47], s65 offen offset:1024 sc1
    s_add_u32 s65, s97, 5
    s_and_b32 s65, s65, 7
    s_lshl_b32 s65, s65, 12
    s_add_u32 s65, s65, s92
    buffer_load_dwordx4 v[20:23], v6, s[44:47], s65 offen offset:0 sc1
    buffer_load_dwordx4 v[24:27], v6, s[44:47], s65 offen offset:1024 sc1
    s_add_u32 s65, s97, 6
    s_and_b32 s65, s65, 7
    s_lshl_b32 s65, s65, 12
    s_add_u32 s65, s65, s92
    buffer_load_dwordx4 v[32:35], v6, s[44:47], s65 offen offset:0 sc1
    buffer_load_dwordx4 v[40:43], v6, s[44:47], s65 offen offset:1024 sc1
    s_add_u32 s65, s97, 7
    s_and_b32 s65, s65, 7
    s_lshl_b32 s65, s65, 12
    s_add_u32 s65, s65, s92
    buffer_load_dwordx4 v[44:47], v6, s[44:47], s65 offen offset:0 sc1
    buffer_load_dwordx4 v[48:51], v6, s[44:47], s65 offen offset:1024 sc1
    s_branch L_po2b
L_po2:
    s_waitcnt vmcnt(12)
    s_barrier
L_po2b:
    s_add_u32 s68, s3, 16
    s_cmp_ge_u32 s68, 22
    s_cselect_b32 s54, 22, 0
    s_sub_u32 s68, s68, s54
    s_lshl_b32 s68, s68, 18
    s_add_u32 m0, s69, 98304
    s_nop 0
    buffer_load_dwordx4 v60, s[28:31], s68 offen lds
    s_add_u32 m0, s69, 99328
    s_nop 0
    buffer_load_dwordx4 v61, s[28:31], s68 offen lds
    s_add_u32 s68, s3, 17
    s_cmp_ge_u32 s68, 22
    s_cselect_b32 s54, 22, 0
    s_sub_u32 s68, s68, s54
    s_lshl_b32 s68, s68, 18
    s_add_u32 m0, s69, 106496
    s_nop 0
    buffer_load_dwordx4 v60, s[28:31], s68 offen lds
    s_add_u32 m0, s69, 107520
    s_nop 0
    buffer_load_dwordx4 v61, s[28:31], s68 offen lds
    v_cmp_gt_u32 vcc, 16, v1
    s_nop 1
    v_cndmask_b32 v10, v59, v58, vcc
    buffer_load_dwordx2 v[8:9], v10, s[44:47], 0 offen sc1
    s_cmp_eq_u32 s67, 0
    s_cbranch_scc1 L_po3
    s_cmp_eq_u32 s67, 1
    s_cbranch_scc1 L_po3a
    s_waitcnt vmcnt(13)
    v_mfma_f32_32x32x16_bf16 v[64:79], v[128:131], v[96:99], 0
    v_mfma_f32_32x32x16_bf16 v[80:95], v[132:135], v[96:99], 0
    v_mfma_f32_32x32x16_bf16 v[64:79], v[136:139], v[100:103], v[64:79]
    v_mfma_f32_32x32x16_bf16 v[80:95], v[140:143], v[100:103], v[80:95]
    v_mfma_f32_32x32x16_bf16 v[64:79], v[144:147], v[104:107], v[64:79]
    v_mfma_f32_32x32x16_bf16 v[80:95], v[148:151], v[104:107], v[80:95]
    v_mfma_f32_32x32x16_bf16 v[64:79], v[152:155], v[108:111], v[64:79]
    v_mfma_f32_32x32x16_bf16 v[80:95], v[156:159], v[108:111], v[80:95]
    v_mfma_f32_32x32x16_bf16 v[64:79], v[160:163], v[112:115], v[64:79]
    v_mfma_f32_32x32x16_bf16 v[80:95], v[164:167], v[112:115], v[80:95]
    v_mfma_f32_32x32x16_bf16 v[64:79], v[168:171], v[116:119], v[64:79]
    v_mfma_f32_32x32x16_bf16 v[80:95], v[172:175], v[116:119], v[80:95]
    v_mfma_f32_32x32x16_bf16 v[64:79], v[176:179], v[120:123], v[64:79]
    v_mfma_f32_32x32x16_bf16 v[80:95], v[180:183], v[120:123], v[80:95]
    v_mfma_f32_32x32x16_bf16 v[64:79], v[184:187], v[124:127], v[64:79]
    v_mfma_f32_32x32x16_bf16 v[80:95], v[188:191], v[124:127], v[80:95]
    s_waitcnt vmcnt(5)
L_po3a:
    v_mfma_f32_32x32x16_bf16 v[64:79], v[192:195], v[12:15], v[64:79]
    v_mfma_f32_32x32x16_bf16 v[80:95], v[196:199], v[12:15], v[80:95]
    v_mfma_f32_32x32x16_bf16 v[64:79], v[200:203], v[16:19], v[64:79]
    v_mfma_f32_32x32x16_bf16 v[80:95], v[204:207], v[16:19], v[80:95]
    v_mfma_f32_32x32x16_bf16 v[64:79], v[208:211], v[20:23], v[64:79]
    v_mfma_f32_32x32x16_bf16 v[80:95], v[212:215], v[20:23], v[80:95]
    v_mfma_f32_32x32x16_bf16 v[64:79], v[216:219], v[24:27], v[64:79]
    v_mfma_f32_32x32x16_bf16 v[80:95], v[220:223], v[24:27], v[80:95]
    v_mfma_f32_32x32x16_bf16 v[64:79], v[224:227], v[32:35], v[64:79]
    v_mfma_f32_32x32x16_bf16 v[80:95], v[228:231], v[32:35], v[80:95]
    v_mfma_f32_32x32x16_bf16 v[64:79], v[232:235], v[40:43], v[64:79]
    v_mfma_f32_32x32x16_bf16 v[80:95], v[236:239], v[40:43], v[80:95]
    v_mfma_f32_32x32x16_bf16 v[64:79], v[240:243], v[44:47], v[64:79]
    v_mfma_f32_32x32x16_bf16 v[80:95], v[244:247], v[44:47], v[80:95]
    v_mfma_f32_32x32x16_bf16 v[64:79], v[248:251], v[48:51], v[64:79]
    v_mfma_f32_32x32x16_bf16 v[80:95], v[252:255], v[48:51], v[80:95]
L_po3:
    s_waitcnt vmcnt(0)
    s_barrier
    v_add_u32 v55, 83968, v54
    s_mov_b32 s96, 0
L_pw:
    v_cmp_ne_u64 vcc, s[52:53], v[8:9]
    s_cmp_eq_u32 s67, 0
    s_cbranch_scc1 L_pw2
    s_and_b32 s54, vcc_lo, 0xffff
    s_cbranch_scc0 L_pu2
    s_branch L_pu
L_pw2:
    s_and_b32 s54, vcc_lo, 0xffff
    s_cbranch_scc0 L_plate
    s_and_b32 s54, vcc_lo, 0xff0000
    s_cbranch_scc0 L_pearly
    s_add_u32 s96, s96, 1
    s_cmp_gt_u32 s96, 20000
    s_cbranch_scc1 L_plate
    s_sleep 1
    s_mov_b64 exec, 0xffffff
    buffer_load_dwordx2 v[8:9], v10, s[44:47], 0 offen sc1
    s_waitcnt vmcnt(0)
    s_mov_b64 exec, -1
    s_branch L_pw
L_pearly:
    s_add_u32 s65, s97, 0
    s_and_b32 s65, s65, 7
    s_lshl_b32 s65, s65, 12
    s_add_u32 s65, s65, s92
    buffer_load_dwordx4 v[96:99], v6, s[44:47], s65 offen offset:0 sc1
    buffer_load_dwordx4 v[100:103], v6, s[44:47], s65 offen offset:1024 sc1
    s_add_u32 s65, s97, 1
    s_and_b32 s65, s65, 7
    s_lshl_b32 s65, s65, 12
    s_add_u32 s65, s65, s92
    buffer_load_dwordx4 v[104:107], v6, s[44:47], s65 offen offset:0 sc1
    buffer_load_dwordx4 v[108:111], v6, s[44:47], s65 offen offset:1024 sc1
    s_add_u32 s65, s97, 2
    s_and_b32 s65, s65, 7
    s_lshl_b32 s65, s65, 12
    s_add_u32 s65, s65, s92
    buffer_load_dwordx4 v[112:115], v6, s[44:47], s65 offen offset:0 sc1
    buffer_load_dwordx4 v[116:119], v6, s[44:47], s65 offen offset:1024 sc1
    s_add_u32 s65, s97, 3
    s_and_b32 s65, s65, 7
    s_lshl_b32 s65, s65, 12
    s_add_u32 s65, s65, s92
    buffer_load_dwordx4 v[120:123], v6, s[44:47], s65 offen offset:0 sc1
    buffer_load_dwordx4 v[124:127], v6, s[44:47], s65 offen offset:1024 sc1
    s_add_u32 s65, s97, 4
    s_and_b32 s65, s65, 7
    s_lshl_b32 s65, s65, 12
    s_add_u32 s65, s65, s92
    buffer_load_dwordx4 v[12:15], v6, s[44:47], s65 offen offset:0 sc1
    buffer_load_dwordx4 v[16:19], v6, s[44:47], s65 offen offset:1024 sc1
    s_add_u32 s65, s97, 5
    s_and_b32 s65, s65, 7
    s_lshl_b32 s65, s65, 12
    s_add_u32 s65, s65, s92
    buffer_load_dwordx4 v[20:23], v6, s[44:47], s65 offen offset:0 sc1
    buffer_load_dwordx4 v[24:27], v6, s[44:47], s65 offen offset:1024 sc1
    s_add_u32 s65, s97, 6
    s_and_b32 s65, s65, 7
    s_lshl_b32 s65, s65, 12
    s_add_u32 s65, s65, s92
    buffer_load_dwordx4 v[32:35], v6, s[44:47], s65 offen offset:0 sc1
    buffer_load_dwordx4 v[40:43], v6, s[44:47], s65 offen offset:1024 sc1
    s_add_u32 s65, s97, 7
    s_and_b32 s65, s65, 7
    s_lshl_b32 s65, s65, 12
    s_add_u32 s65, s65, s92
    buffer_load_dwordx4 v[44:47], v6, s[44:47], s65 offen offset:0 sc1
    buffer_load_dwordx4 v[48:51], v6, s[44:47], s65 offen offset:1024 sc1
    s_waitcnt vmcnt(14)
    v_mfma_f32_32x32x16_bf16 v[64:79], v[128:131], v[96:99], 0
    v_mfma_f32_32x32x16_bf16 v[80:95], v[132:135], v[96:99], 0
    v_mfma_f32_32x32x16_bf16 v[64:79], v[136:139], v[100:103], v[64:79]
    v_mfma_f32_32x32x16_bf16 v[80:95], v[140:143], v[100:103], v[80:95]
    s_waitcnt vmcnt(12)
    v_mfma_f32_32x32x16_bf16 v[64:79], v[144:147], v[104:107], v[64:79]
    v_mfma_f32_32x32x16_bf16 v[80:95], v[148:151], v[104:107], v[80:95]
    v_mfma_f32_32x32x16_bf16 v[64:79], v[152:155], v[108:111], v[64:79]
    v_mfma_f32_32x32x16_bf16 v[80:95], v[156:159], v[108:111], v[80:95]
    s_waitcnt vmcnt(10)
    v_mfma_f32_32x32x16_bf16 v[64:79], v[160:163], v[112:115], v[64:79]
    v_mfma_f32_32x32x16_bf16 v[80:95], v[164:167], v[112:115], v[80:95]
    v_mfma_f32_32x32x16_bf16 v[64:79], v[168:171], v[116:119], v[64:79]
    v_mfma_f32_32x32x16_bf16 v[80:95], v[172:175], v[116:119], v[80:95]
    s_waitcnt vmcnt(8)
    v_mfma_f32_32x32x16_bf16 v[64:79], v[176:179], v[120:123], v[64:79]
    v_mfma_f32_32x32x16_bf16 v[80:95], v[180:183], v[120:123], v[80:95]
    v_mfma_f32_32x32x16_bf16 v[64:79], v[184:187], v[124:127], v[64:79]
    v_mfma_f32_32x32x16_bf16 v[80:95], v[188:191], v[124:127], v[80:95]
    s_waitcnt vmcnt(6)
    v_mfma_f32_32x32x16_bf16 v[64:79], v[192:195], v[12:15], v[64:79]
    v_mfma_f32_32x32x16_bf16 v[80:95], v[196:199], v[12:15], v[80:95]
    v_mfma_f32_32x32x16_bf16 v[64:79], v[200:203], v[16:19], v[64:79]
    v_mfma_f32_32x32x16_bf16 v[80:95], v[204:207], v[16:19], v[80:95]
    s_waitcnt vmcnt(4)
    v_mfma_f32_32x32x16_bf16 v[64:79], v[208:211], v[20:23], v[64:79]
    v_mfma_f32_32x32x16_bf16 v[80:95], v[212:215], v[20:23], v[80:95]
    v_mfma_f32_32x32x16_bf16 v[64:79], v[216:219], v[24:27], v[64:79]
    v_mfma_f32_32x32x16_bf16 v[80:95], v[220:223], v[24:27], v[80:95]
    s_waitcnt vmcnt(2)
    v_mfma_f32_32x32x16_bf16 v[64:79], v[224:227], v[32:35], v[64:79]
    v_mfma_f32_32x32x16_bf16 v[80:95], v[228:231], v[32:35], v[80:95]
    v_mfma_f32_32x32x16_bf16 v[64:79], v[232:235], v[40:43], v[64:79]
    v_mfma_f32_32x32x16_bf16 v[80:95], v[236:239], v[40:43], v[80:95]
    s_waitcnt vmcnt(0)
    v_mfma_f32_32x32x16_bf16 v[64:79], v[240:243], v[44:47], v[64:79]
    v_mfma_f32_32x32x16_bf16 v[80:95], v[244:247], v[44:47], v[80:95]
    v_mfma_f32_32x32x16_bf16 v[64:79], v[248:251], v[48:51], v[64:79]
    v_mfma_f32_32x32x16_bf16 v[80:95], v[252:255], v[48:51], v[80:95]
L_pu:
    s_mov_b32 s96, 0
    s_mov_b64 exec, 0x7fff
Lpoll_23:
    buffer_load_dwordx2 v[8:9], v58, s[44:47], 0 offen sc1
    s_waitcnt vmcnt(0)
    v_cmp_ne_u64 vcc, s[52:53], v[8:9]
    s_add_u32 s96, s96, 1
    s_cmp_eq_u64 vcc, 0
    s_cbranch_scc1 Lpd_24
    s_mov_b64 exec, vcc
    s_cmp_gt_u32 s96, 20000
    s_cbranch_scc1 Lpd_24
    s_sleep 1
    s_branch Lpoll_23
Lpd_24:
    s_mov_b64 exec, -1
L_pu2:
    s_add_u32 m0, s69, 114688
    s_nop 0
    buffer_load_dwordx4 v6, s[44:47], s70 offen sc1 lds
    buffer_load_dwordx4 v6, s[44:47], s70 offen offset:1024 sc1 lds
    s_add_u32 m0, s69, 122880
    s_nop 0
    buffer_load_dwordx4 v6, s[44:47], s71 offen sc1 lds
    buffer_load_dwordx4 v6, s[44:47], s71 offen offset:1024 sc1 lds
    s_add_u32 m0, s69, 16384
    s_nop 0
    buffer_load_dwordx4 v6, s[44:47], s72 offen sc1 lds
    buffer_load_dwordx4 v6, s[44:47], s72 offen offset:1024 sc1 lds
    s_add_u32 m0, s69, 24576
    s_nop 0
    buffer_load_dwordx4 v6, s[44:47], s73 offen sc1 lds
    buffer_load_dwordx4 v6, s[44:47], s73 offen offset:1024 sc1 lds
    s_add_u32 m0, s69, 32768
    s_nop 0
    buffer_load_dwordx4 v6, s[44:47], s74 offen sc1 lds
    buffer_load_dwordx4 v6, s[44:47], s74 offen offset:1024 sc1 lds
    s_add_u32 m0, s69, 40960
    s_nop 0
    buffer_load_dwordx4 v6, s[44:47], s75 offen sc1 lds
    buffer_load_dwordx4 v6, s[44:47], s75 offen offset:1024 sc1 lds
    s_add_u32 m0, s69, 49152
    s_nop 0
    buffer_load_dwordx4 v6, s[44:47], s76 offen sc1 lds
    buffer_load_dwordx4 v6, s[44:47], s76 offen offset:1024 sc1 lds
    s_waitcnt vmcnt(10)
    s_barrier
    s_add_u32 m0, s69, 57344
    s_nop 0
    buffer_load_dwordx4 v6, s[44:47], s77 offen sc1 lds
    buffer_load_dwordx4 v6, s[44:47], s77 offen offset:1024 sc1 lds
    s_add_u32 m0, s69, 65536
    s_nop 0
    buffer_load_dwordx4 v6, s[44:47], s78 offen sc1 lds
    buffer_load_dwordx4 v6, s[44:47], s78 offen offset:1024 sc1 lds
    s_waitcnt vmcnt(10)
    s_barrier
    s_add_u32 m0, s69, 73728
    s_nop 0
    buffer_load_dwordx4 v6, s[44:47], s79 offen sc1 lds
    buffer_load_dwordx4 v6, s[44:47], s79 offen offset:1024 sc1 lds
    s_add_u32 m0, s69, 81920
    s_nop 0
    buffer_load_dwordx4 v6, s[44:47], s80 offen sc1 lds
    buffer_load_dwordx4 v6, s[44:47], s80 offen offset:1024 sc1 lds
    s_waitcnt vmcnt(10)
    s_barrier
    s_add_u32 m0, s69, 90112
    s_nop 0
    buffer_load_dwordx4 v6, s[44:47], s81 offen sc1 lds
    buffer_load_dwordx4 v6, s[44:47], s81 offen offset:1024 sc1 lds
    s_add_u32 m0, s69, 98304
    s_nop 0
    buffer_load_dwordx4 v6, s[44:47], s82 offen sc1 lds
    buffer_load_dwordx4 v6, s[44:47], s82 offen offset:1024 sc1 lds
    s_waitcnt vmcnt(10)
    s_barrier
    s_add_u32 m0, s69, 106496
    s_nop 0
    buffer_load_dwordx4 v6, s[44:47], s83 offen sc1 lds
    buffer_load_dwordx4 v6, s[44:47], s83 offen offset:1024 sc1 lds
    s_add_u32 m0, s69, 0
    s_nop 0
    buffer_load_dwordx4 v6, s[44:47], s84 offen sc1 lds
    buffer_load_dwordx4 v6, s[44:47], s84 offen offset:1024 sc1 lds
    s_add_u32 m0, s69, 8192
    s_nop 0
    buffer_load_dwordx4 v6, s[44:47], s85 offen sc1 lds
    buffer_load_dwordx4 v6, s[44:47], s85 offen offset:1024 sc1 lds
    s_waitcnt vmcnt(10)
    s_barrier
    s_add_u32 m0, s69, 114688
    s_nop 0
    buffer_load_dwordx4 v6, s[44:47], s86 offen sc1 lds
    buffer_load_dwordx4 v6, s[44:47], s86 offen offset:1024 sc1 lds
    s_add_u32 m0, s69, 122880
    s_nop 0
    buffer_load_dwordx4 v6, s[44:47], s87 offen sc1 lds
    buffer_load_dwordx4 v6, s[44:47], s87 offen offset:1024 sc1 lds
    s_add_u32 m0, s69, 16384
    s_nop 0
    buffer_load_dwordx4 v6, s[44:47], s88 offen sc1 lds
    buffer_load_dwordx4 v6, s[44:47], s88 offen offset:1024 sc1 lds
    s_waitcnt vmcnt(10)
    s_barrier
    s_add_u32 m0, s69, 24576
    s_nop 0
    buffer_load_dwordx4 v6, s[44:47], s89 offen sc1 lds
    buffer_load_dwordx4 v6, s[44:47], s89 offen offset:1024 sc1 lds
    s_add_u32 m0, s69, 32768
    s_nop 0
    buffer_load_dwordx4 v6, s[44:47], s90 offen sc1 lds
    buffer_load_dwordx4 v6, s[44:47], s90 offen offset:1024 sc1 lds
    s_add_u32 m0, s69, 40960
    s_nop 0
    buffer_load_dwordx4 v6, s[44:47], s91 offen sc1 lds
    buffer_load_dwordx4 v6, s[44:47], s91 offen offset:1024 sc1 lds
    s_waitcnt vmcnt(10)
    s_barrier
    s_waitcnt vmcnt(4)
    s_barrier
    s_waitcnt vmcnt(0)
    s_barrier
    s_branch L_pdone
L_plate:
    s_add_u32 m0, s69, 114688
    s_nop 0
    buffer_load_dwordx4 v6, s[44:47], s70 offen sc1 lds
    buffer_load_dwordx4 v6, s[44:47], s70 offen offset:1024 sc1 lds
    s_add_u32 m0, s69, 122880
    s_nop 0
    buffer_load_dwordx4 v6, s[44:47], s71 offen sc1 lds
    buffer_load_dwordx4 v6, s[44:47], s71 offen offset:1024 sc1 lds
    s_add_u32 m0, s69, 16384
    s_nop 0
    buffer_load_dwordx4 v6, s[44:47], s72 offen sc1 lds
    buffer_load_dwordx4 v6, s[44:47], s72 offen offset:1024 sc1 lds
    s_add_u32 m0, s69, 24576
    s_nop 0
    buffer_load_dwordx4 v6, s[44:47], s73 offen sc1 lds
    buffer_load_dwordx4 v6, s[44:47], s73 offen offset:1024 sc1 lds
    s_add_u32 m0, s69, 32768
    s_nop 0
    buffer_load_dwordx4 v6, s[44:47], s74 offen sc1 lds
    buffer_load_dwordx4 v6, s[44:47], s74 offen offset:1024 sc1 lds
    s_add_u32 m0, s69, 40960
    s_nop 0
    buffer_load_dwordx4 v6, s[44:47], s75 offen sc1 lds
    buffer_load_dwordx4 v6, s[44:47], s75 offen offset:1024 sc1 lds
    s_add_u32 m0, s69, 49152
    s_nop 0
    buffer_load_dwordx4 v6, s[44:47], s76 offen sc1 lds
    buffer_load_dwordx4 v6, s[44:47], s76 offen offset:1024 sc1 lds
    buffer_load_dwordx2 v[8:9], v59, s[44:47], 0 offen sc1
    s_waitcnt vmcnt(11)
    s_barrier
    s_add_u32 m0, s69, 57344
    s_nop 0
    buffer_load_dwordx4 v6, s[44:47], s77 offen sc1 lds
    buffer_load_dwordx4 v6, s[44:47], s77 offen offset:1024 sc1 lds
    s_add_u32 m0, s69, 65536
    s_nop 0
    buffer_load_dwordx4 v6, s[44:47], s78 offen sc1 lds
    buffer_load_dwordx4 v6, s[44:47], s78 offen offset:1024 sc1 lds
    s_waitcnt vmcnt(4)
    v_cmp_ne_u64 vcc, s[52:53], v[8:9]
    s_nop 0
    s_cmp_eq_u64 vcc, 0
    s_cbranch_scc1 Lok_25
    s_mov_b32 s96, 0
    s_mov_b64 exec, -1
Lpoll_26:
    buffer_load_dwordx2 v[8:9], v59, s[44:47], 0 offen sc1
    s_waitcnt vmcnt(0)
    v_cmp_ne_u64 vcc, s[52:53], v[8:9]
    s_add_u32 s96, s96, 1
    s_cmp_eq_u64 vcc, 0
    s_cbranch_scc1 Lpd_27
    s_mov_b64 exec, vcc
    s_cmp_gt_u32 s96, 20000
    s_cbranch_scc1 Lpd_27
    s_sleep 1
    s_branch Lpoll_26
Lpd_27:
    s_mov_b64 exec, -1
Lok_25:
    s_add_u32 s65, s97, 0
    s_and_b32 s65, s65, 7
    s_lshl_b32 s65, s65, 12
    s_add_u32 s65, s65, s92
    buffer_load_dwordx4 v[96:99], v6, s[44:47], s65 offen offset:0 sc1
    buffer_load_dwordx4 v[100:103], v6, s[44:47], s65 offen offset:1024 sc1
    s_add_u32 s65, s97, 1
    s_and_b32 s65, s65, 7
    s_lshl_b32 s65, s65, 12
    s_add_u32 s65, s65, s92
    buffer_load_dwordx4 v[104:107], v6, s[44:47], s65 offen offset:0 sc1
    buffer_load_dwordx4 v[108:111], v6, s[44:47], s65 offen offset:1024 sc1
    s_add_u32 s65, s97, 2
    s_and_b32 s65, s65, 7
    s_lshl_b32 s65, s65, 12
    s_add_u32 s65, s65, s92
    buffer_load_dwordx4 v[112:115], v6, s[44:47], s65 offen offset:0 sc1
    buffer_load_dwordx4 v[116:119], v6, s[44:47], s65 offen offset:1024 sc1
    s_add_u32 s65, s97, 3
    s_and_b32 s65, s65, 7
    s_lshl_b32 s65, s65, 12
    s_add_u32 s65, s65, s92
    buffer_load_dwordx4 v[120:123], v6, s[44:47], s65 offen offset:0 sc1
    buffer_load_dwordx4 v[124:127], v6, s[44:47], s65 offen offset:1024 sc1
    s_barrier
    s_add_u32 m0, s69, 73728
    s_nop 0
    buffer_load_dwordx4 v6, s[44:47], s79 offen sc1 lds
    buffer_load_dwordx4 v6, s[44:47], s79 offen offset:1024 sc1 lds
    s_add_u32 m0, s69, 81920
    s_nop 0
    buffer_load_dwordx4 v6, s[44:47], s80 offen sc1 lds
    buffer_load_dwordx4 v6, s[44:47], s80 offen offset:1024 sc1 lds
    s_barrier
    s_add_u32 m0, s69, 90112
    s_nop 0
    buffer_load_dwordx4 v6, s[44:47], s81 offen sc1 lds
    buffer_load_dwordx4 v6, s[44:47], s81 offen offset:1024 sc1 lds
    s_add_u32 m0, s69, 98304
    s_nop 0
    buffer_load_dwordx4 v6, s[44:47], s82 offen sc1 lds
    buffer_load_dwordx4 v6, s[44:47], s82 offen offset:1024 sc1 lds
    s_add_u32 s65, s97, 4
    s_and_b32 s65, s65, 7
    s_lshl_b32 s65, s65, 12
    s_add_u32 s65, s65, s92
    buffer_load_dwordx4 v[12:15], v6, s[44:47], s65 offen offset:0 sc1
    buffer_load_dwordx4 v[16:19], v6, s[44:47], s65 offen offset:1024 sc1
    s_add_u32 s65, s97, 5
    s_and_b32 s65, s65, 7
    s_lshl_b32 s65, s65, 12
    s_add_u32 s65, s65, s92
    buffer_load_dwordx4 v[20:23], v6, s[44:47], s65 offen offset:0 sc1
    buffer_load_dwordx4 v[24:27], v6, s[44:47], s65 offen offset:1024 sc1
    s_add_u32 s65, s97, 6
    s_and_b32 s65, s65, 7
    s_lshl_b32 s65, s65, 12
    s_add_u32 s65, s65, s92
    buffer_load_dwordx4 v[32:35], v6, s[44:47], s65 offen offset:0 sc1
    buffer_load_dwordx4 v[40:43], v6, s[44:47], s65 offen offset:1024 sc1
    s_add_u32 s65, s97, 7
    s_and_b32 s65, s65, 7
    s_lshl_b32 s65, s65, 12
    s_add_u32 s65, s65, s92
    buffer_load_dwordx4 v[44:47], v6, s[44:47], s65 offen offset:0 sc1
    buffer_load_dwordx4 v[48:51], v6, s[44:47], s65 offen offset:1024 sc1
    s_waitcnt vmcnt(26)
    s_barrier
    s_add_u32 m0, s69, 106496
    s_nop 0
    buffer_load_dwordx4 v6, s[44:47], s83 offen sc1 lds
    buffer_load_dwordx4 v6, s[44:47], s83 offen offset:1024 sc1 lds
    s_add_u32 m0, s69, 0
    s_nop 0
    buffer_load_dwordx4 v6, s[44:47], s84 offen sc1 lds
    buffer_load_dwordx4 v6, s[44:47], s84 offen offset:1024 sc1 lds
    s_add_u32 m0, s69, 8192
    s_nop 0
    buffer_load_dwordx4 v6, s[44:47], s85 offen sc1 lds
    buffer_load_dwordx4 v6, s[44:47], s85 offen offset:1024 sc1 lds
    s_waitcnt vmcnt(28)
    v_mfma_f32_32x32x16_bf16 v[64:79], v[128:131], v[96:99], 0
    v_mfma_f32_32x32x16_bf16 v[80:95], v[132:135], v[96:99], 0
    v_mfma_f32_32x32x16_bf16 v[64:79], v[136:139], v[100:103], v[64:79]
    v_mfma_f32_32x32x16_bf16 v[80:95], v[140:143], v[100:103], v[80:95]
    s_waitcnt vmcnt(26)
    v_mfma_f32_32x32x16_bf16 v[64:79], v[144:147], v[104:107], v[64:79]
    v_mfma_f32_32x32x16_bf16 v[80:95], v[148:151], v[104:107], v[80:95]
    v_mfma_f32_32x32x16_bf16 v[64:79], v[152:155], v[108:111], v[64:79]
    v_mfma_f32_32x32x16_bf16 v[80:95], v[156:159], v[108:111], v[80:95]
    s_waitcnt vmcnt(18)
    s_barrier
    s_add_u32 m0, s69, 114688
    s_nop 0
    buffer_load_dwordx4 v6, s[44:47], s86 offen sc1 lds
    buffer_load_dwordx4 v6, s[44:47], s86 offen offset:1024 sc1 lds
    s_add_u32 m0, s69, 122880
    s_nop 0
    buffer_load_dwordx4 v6, s[44:47], s87 offen sc1 lds
    buffer_load_dwordx4 v6, s[44:47], s87 offen offset:1024 sc1 lds
    s_add_u32 m0, s69, 16384
    s_nop 0
    buffer_load_dwordx4 v6, s[44:47], s88 offen sc1 lds
    buffer_load_dwordx4 v6, s[44:47], s88 offen offset:1024 sc1 lds
    v_mfma_f32_32x32x16_bf16 v[64:79], v[160:163], v[112:115], v[64:79]
    v_mfma_f32_32x32x16_bf16 v[80:95], v[164:167], v[112:115], v[80:95]
    v_mfma_f32_32x32x16_bf16 v[64:79], v[168:171], v[116:119], v[64:79]
    v_mfma_f32_32x32x16_bf16 v[80:95], v[172:175], v[116:119], v[80:95]
    v_mfma_f32_32x32x16_bf16 v[64:79], v[176:179], v[120:123], v[64:79]
    v_mfma_f32_32x32x16_bf16 v[80:95], v[180:183], v[120:123], v[80:95]
    v_mfma_f32_32x32x16_bf16 v[64:79], v[184:187], v[124:127], v[64:79]
    v_mfma_f32_32x32x16_bf16 v[80:95], v[188:191], v[124:127], v[80:95]
    s_waitcnt vmcnt(10)
    s_barrier
    s_add_u32 m0, s69, 24576
    s_nop 0
    buffer_load_dwordx4 v6, s[44:47], s89 offen sc1 lds
    buffer_load_dwordx4 v6, s[44:47], s89 offen offset:1024 sc1 lds
    s_add_u32 m0, s69, 32768
    s_nop 0
    buffer_load_dwordx4 v6, s[44:47], s90 offen sc1 lds
    buffer_load_dwordx4 v6, s[44:47], s90 offen offset:1024 sc1 lds
    s_add_u32 m0, s69, 40960
    s_nop 0
    buffer_load_dwordx4 v6, s[44:47], s91 offen sc1 lds
    buffer_load_dwordx4 v6, s[44:47], s91 offen offset:1024 sc1 lds
    v_mfma_f32_32x32x16_bf16 v[64:79], v[192:195], v[12:15], v[64:79]
    v_mfma_f32_32x32x16_bf16 v[80:95], v[196:199], v[12:15], v[80:95]
    v_mfma_f32_32x32x16_bf16 v[64:79], v[200:203], v[16:19], v[64:79]
    v_mfma_f32_32x32x16_bf16 v[80:95], v[204:207], v[16:19], v[80:95]
    v_mfma_f32_32x32x16_bf16 v[64:79], v[208:211], v[20:23], v[64:79]
    v_mfma_f32_32x32x16_bf16 v[80:95], v[212:215], v[20:23], v[80:95]
    v_mfma_f32_32x32x16_bf16 v[64:79], v[216:219], v[24:27], v[64:79]
    v_mfma_f32_32x32x16_bf16 v[80:95], v[220:223], v[24:27], v[80:95]
    s_waitcnt vmcnt(10)
    s_barrier
    v_mfma_f32_32x32x16_bf16 v[64:79], v[224:227], v[32:35], v[64:79]
    v_mfma_f32_32x32x16_bf16 v[80:95], v[228:231], v[32:35], v[80:95]
    v_mfma_f32_32x32x16_bf16 v[64:79], v[232:235], v[40:43], v[64:79]
    v_mfma_f32_32x32x16_bf16 v[80:95], v[236:239], v[40:43], v[80:95]
    v_mfma_f32_32x32x16_bf16 v[64:79], v[240:243], v[44:47], v[64:79]
    v_mfma_f32_32x32x16_bf16 v[80:95], v[244:247], v[44:47], v[80:95]
    v_mfma_f32_32x32x16_bf16 v[64:79], v[248:251], v[48:51], v[64:79]
    v_mfma_f32_32x32x16_bf16 v[80:95], v[252:255], v[48:51], v[80:95]
    s_waitcnt vmcnt(4)
    s_barrier
    s_waitcnt vmcnt(0)
    s_barrier
L_pdone:
    s_nop 7
    s_nop 7
    ds_write_b128 v55, v[64:67] offset:0
    ds_write_b128 v55, v[68:71] offset:32
    ds_write_b128 v55, v[72:75] offset:64
    ds_write_b128 v55, v[76:79] offset:96
    ds_write_b128 v55, v[80:83] offset:128
    ds_write_b128 v55, v[84:87] offset:160
    ds_write_b128 v55, v[88:91] offset:192
    ds_write_b128 v55, v[92:95] offset:224
L_fin:
    v_add_u32 v55, 83968, v57
    v_add_u32 v57, 49152, v57
    v_lshlrev_b32 v52, 16, v52
    v_lshlrev_b32 v40, 16, v36
    v_and_b32 v41, 0xffff0000, v36
    v_lshlrev_b32 v42, 16, v37
    v_and_b32 v43, 0xffff0000, v37
    v_lshlrev_b32 v44, 16, v38
    v_and_b32 v45, 0xffff0000, v38
    v_lshlrev_b32 v46, 16, v39
    v_and_b32 v47, 0xffff0000, v39
    s_waitcnt lgkmcnt(0)
    s_barrier
    ds_read_b128 v[16:19], v57 offset:0
    ds_read_b128 v[20:23], v57 offset:16
    ds_read_b128 v[24:27], v57 offset:17408
    ds_read_b128 v[28:31], v57 offset:17424
    ds_read_b128 v[128:131], v55 offset:0
    ds_read_b128 v[132:135], v55 offset:16
    ds_read_b128 v[136:139], v55 offset:17408
    ds_read_b128 v[140:143], v55 offset:17424
    s_waitcnt lgkmcnt(4)
    v_add_f32 v16, v16, v24
    v_add_f32 v17, v17, v25
    v_add_f32 v18, v18, v26
    v_add_f32 v19, v19, v27
    v_add_f32 v20, v20, v28
    v_add_f32 v21, v21, v29
    v_add_f32 v22, v22, v30
    v_add_f32 v23, v23, v31
    v_add_f32 v16, v16, v52
    v_add_f32 v17, v17, v52
    v_add_f32 v18, v18, v52
    v_add_f32 v19, v19, v52
    v_add_f32 v20, v20, v52
    v_add_f32 v21, v21, v52
    v_add_f32 v22, v22, v52
    v_add_f32 v23, v23, v52
    v_mul_f32 v24, v53, v16
    v_mul_f32 v25, v53, v17
    v_mul_f32 v26, v53, v18
    v_mul_f32 v27, v53, v19
    v_mul_f32 v28, v53, v20
    v_mul_f32 v29, v53, v21
    v_mul_f32 v30, v53, v22
    v_mul_f32 v31, v53, v23
    v_exp_f32 v24, v24
    v_exp_f32 v25, v25
    v_exp_f32 v26, v26
    v_exp_f32 v27, v27
    v_exp_f32 v28, v28
    v_exp_f32 v29, v29
    v_exp_f32 v30, v30
    v_exp_f32 v31, v31
    s_waitcnt lgkmcnt(0)
    v_add_f32 v128, v128, v136
    v_add_f32 v129, v129, v137
    v_add_f32 v130, v130, v138
    v_add_f32 v131, v131, v139
    v_add_f32 v132, v132, v140
    v_add_f32 v133, v133, v141
    v_add_f32 v134, v134, v142
    v_add_f32 v135, v135, v143
    v_mul_f32 v16, v16, v128
    v_mul_f32 v17, v17, v129
    v_mul_f32 v18, v18, v130
    v_mul_f32 v19, v19, v131
    v_mul_f32 v20, v20, v132
    v_mul_f32 v21, v21, v133
    v_mul_f32 v22, v22, v134
    v_mul_f32 v23, v23, v135
    v_add_f32 v24, 1.0, v24
    v_add_f32 v25, 1.0, v25
    v_add_f32 v26, 1.0, v26
    v_add_f32 v27, 1.0, v27
    v_add_f32 v28, 1.0, v28
    v_add_f32 v29, 1.0, v29
    v_add_f32 v30, 1.0, v30
    v_add_f32 v31, 1.0, v31
    v_rcp_f32 v24, v24
    v_rcp_f32 v25, v25
    v_rcp_f32 v26, v26
    v_rcp_f32 v27, v27
    v_rcp_f32 v28, v28
    v_rcp_f32 v29, v29
    v_rcp_f32 v30, v30
    v_rcp_f32 v31, v31
    v_fma_f32 v16, v16, v24, v40
    v_fma_f32 v17, v17, v25, v41
    v_fma_f32 v18, v18, v26, v42
    v_fma_f32 v19, v19, v27, v43
    v_fma_f32 v20, v20, v28, v44
    v_fma_f32 v21, v21, v29, v45
    v_fma_f32 v22, v22, v30, v46
    v_fma_f32 v23, v23, v31, v47
    v_cvt_pk_bf16_f32 v8, v16, v17
    v_cvt_pk_bf16_f32 v9, v18, v19
    v_cvt_pk_bf16_f32 v10, v20, v21
    v_cvt_pk_bf16_f32 v11, v22, v23
    buffer_store_dwordx4 v[8:11], v56, s[36:39], s94 offen sc1
    s_endpgm
L_roleS:
    s_waitcnt vmcnt(0)
    s_mov_b32 s96, 0
Lnp_28:
    v_readfirstlane_b32 s52, v22
    v_readfirstlane_b32 s53, v23
    s_nop 0
    s_xor_b32 s95, s52, s53
    s_cmp_eq_u32 s95, 0x5bd1e995
    s_cbranch_scc1 Lnd_29
    s_add_u32 s96, s96, 1
    s_cmp_gt_u32 s96, 20000
    s_cbranch_scc1 Lnd_29
    s_sleep 1
    buffer_load_dwordx2 v[22:23], v4, s[40:43], 0 offen sc1
    s_waitcnt vmcnt(0)
    s_branch Lnp_28
Lnd_29:
    s_barrier
    s_cmp_lg_u32 s48, 0
    s_cbranch_scc1 Lw0_30
    v_mov_b32 v2, s52
    v_mov_b32 v3, s53
    v_mov_b32 v4, 0
    s_mov_b64 exec, 1
    buffer_store_dwordx2 v[2:3], v4, s[44:47], s86 offen sc1
    s_mov_b64 exec, -1
Lw0_30:
    v_lshrrev_b32 v2, 3, v1
    v_mul_u32_u24 v2, 3072, v2
    v_and_b32 v3, 7, v1
    v_lshl_add_u32 v2, v3, 4, v2
    s_mul_i32 s54, s48, 196608
    s_lshl_b32 s55, s56, 7
    s_add_u32 s54, s54, s55
    buffer_load_dwordx4 v[64:67], v2, s[8:11], s54 offen offset:0
    s_add_u32 s54, s54, 24576
    buffer_load_dwordx4 v[68:71], v2, s[8:11], s54 offen offset:0
    s_add_u32 s54, s54, 24576
    buffer_load_dwordx4 v[72:75], v2, s[8:11], s54 offen offset:0
    s_add_u32 s54, s54, 24576
    buffer_load_dwordx4 v[76:79], v2, s[8:11], s54 offen offset:0
    s_add_u32 s54, s54, 24576
    buffer_load_dwordx4 v[80:83], v2, s[8:11], s54 offen offset:0
    s_add_u32 s54, s54, 24576
    buffer_load_dwordx4 v[84:87], v2, s[8:11], s54 offen offset:0
    s_add_u32 s54, s54, 24576
    buffer_load_dwordx4 v[88:91], v2, s[8:11], s54 offen offset:0
    s_add_u32 s54, s54, 24576
    buffer_load_dwordx4 v[92:95], v2, s[8:11], s54 offen offset:0
    v_mov_b32 v28, 0
    v_mov_b32 v29, 0
    v_mov_b32 v30, 0
    v_mov_b32 v31, 0
    v_lshlrev_b32 v23, 4, v0
    s_lshl_b32 s54, s56, 14
    s_add_u32 s54, s54, 8912896
    buffer_store_dwordx4 v[28:31], v23, s[44:47], s54 offen sc1
    s_add_u32 s54, s54, 8192
    buffer_store_dwordx4 v[28:31], v23, s[44:47], s54 offen sc1
    s_waitcnt vmcnt(9)
    v_lshlrev_b32 v160, 16, v64
    v_and_b32 v161, 0xffff0000, v64
    v_lshlrev_b32 v162, 16, v65
    v_and_b32 v163, 0xffff0000, v65
    v_lshlrev_b32 v164, 16, v66
    v_and_b32 v165, 0xffff0000, v66
    v_lshlrev_b32 v166, 16, v67
    v_and_b32 v167, 0xffff0000, v67
    s_waitcnt vmcnt(8)
    v_lshlrev_b32 v40, 16, v68
    v_and_b32 v41, 0xffff0000, v68
    v_lshlrev_b32 v42, 16, v69
    v_and_b32 v43, 0xffff0000, v69
    v_lshlrev_b32 v44, 16, v70
    v_and_b32 v45, 0xffff0000, v70
    v_lshlrev_b32 v46, 16, v71
    v_and_b32 v47, 0xffff0000, v71
    v_add_f32 v160, v160, v40
    v_add_f32 v161, v161, v41
    v_add_f32 v162, v162, v42
    v_add_f32 v163, v163, v43
    v_add_f32 v164, v164, v44
    v_add_f32 v165, v165, v45
    v_add_f32 v166, v166, v46
    v_add_f32 v167, v167, v47
    s_waitcnt vmcnt(7)
    v_lshlrev_b32 v40, 16, v72
    v_and_b32 v41, 0xffff0000, v72
    v_lshlrev_b32 v42, 16, v73
    v_and_b32 v43, 0xffff0000, v73
    v_lshlrev_b32 v44, 16, v74
    v_and_b32 v45, 0xffff0000, v74
    v_lshlrev_b32 v46, 16, v75
    v_and_b32 v47, 0xffff0000, v75
    v_add_f32 v160, v160, v40
    v_add_f32 v161, v161, v41
    v_add_f32 v162, v162, v42
    v_add_f32 v163, v163, v43
    v_add_f32 v164, v164, v44
    v_add_f32 v165, v165, v45
    v_add_f32 v166, v166, v46
    v_add_f32 v167, v167, v47
    s_waitcnt vmcnt(6)
    v_lshlrev_b32 v40, 16, v76
    v_and_b32 v41, 0xffff0000, v76
    v_lshlrev_b32 v42, 16, v77
    v_and_b32 v43, 0xffff0000, v77
    v_lshlrev_b32 v44, 16, v78
    v_and_b32 v45, 0xffff0000, v78
    v_lshlrev_b32 v46, 16, v79
    v_and_b32 v47, 0xffff0000, v79
    v_add_f32 v160, v160, v40
    v_add_f32 v161, v161, v41
    v_add_f32 v162, v162, v42
    v_add_f32 v163, v163, v43
    v_add_f32 v164, v164, v44
    v_add_f32 v165, v165, v45
    v_add_f32 v166, v166, v46
    v_add_f32 v167, v167, v47
    s_waitcnt vmcnt(5)
    v_lshlrev_b32 v40, 16, v80
    v_and_b32 v41, 0xffff0000, v80
    v_lshlrev_b32 v42, 16, v81
    v_and_b32 v43, 0xffff0000, v81
    v_lshlrev_b32 v44, 16, v82
    v_and_b32 v45, 0xffff0000, v82
    v_lshlrev_b32 v46, 16, v83
    v_and_b32 v47, 0xffff0000, v83
    v_add_f32 v160, v160, v40
    v_add_f32 v161, v161, v41
    v_add_f32 v162, v162, v42
    v_add_f32 v163, v163, v43
    v_add_f32 v164, v164, v44
    v_add_f32 v165, v165, v45
    v_add_f32 v166, v166, v46
    v_add_f32 v167, v167, v47
    s_waitcnt vmcnt(4)
    v_lshlrev_b32 v40, 16, v84
    v_and_b32 v41, 0xffff0000, v84
    v_lshlrev_b32 v42, 16, v85
    v_and_b32 v43, 0xffff0000, v85
    v_lshlrev_b32 v44, 16, v86
    v_and_b32 v45, 0xffff0000, v86
    v_lshlrev_b32 v46, 16, v87
    v_and_b32 v47, 0xffff0000, v87
    v_add_f32 v160, v160, v40
    v_add_f32 v161, v161, v41
    v_add_f32 v162, v162, v42
    v_add_f32 v163, v163, v43
    v_add_f32 v164, v164, v44
    v_add_f32 v165, v165, v45
    v_add_f32 v166, v166, v46
    v_add_f32 v167, v167, v47
    s_waitcnt vmcnt(3)
    v_lshlrev_b32 v40, 16, v88
    v_and_b32 v41, 0xffff0000, v88
    v_lshlrev_b32 v42, 16, v89
    v_and_b32 v43, 0xffff0000, v89
    v_lshlrev_b32 v44, 16, v90
    v_and_b32 v45, 0xffff0000, v90
    v_lshlrev_b32 v46, 16, v91
    v_and_b32 v47, 0xffff0000, v91
    v_add_f32 v160, v160, v40
    v_add_f32 v161, v161, v41
    v_add_f32 v162, v162, v42
    v_add_f32 v163, v163, v43
    v_add_f32 v164, v164, v44
    v_add_f32 v165, v165, v45
    v_add_f32 v166, v166, v46
    v_add_f32 v167, v167, v47
    s_waitcnt vmcnt(2)
    v_lshlrev_b32 v40, 16, v92
    v_and_b32 v41, 0xffff0000, v92
    v_lshlrev_b32 v42, 16, v93
    v_and_b32 v43, 0xffff0000, v93
    v_lshlrev_b32 v44, 16, v94
    v_and_b32 v45, 0xffff0000, v94
    v_lshlrev_b32 v46, 16, v95
    v_and_b32 v47, 0xffff0000, v95
    v_add_f32 v160, v160, v40
    v_add_f32 v161, v161, v41
    v_add_f32 v162, v162, v42
    v_add_f32 v163, v163, v43
    v_add_f32 v164, v164, v44
    v_add_f32 v165, v165, v45
    v_add_f32 v166, v166, v46
    v_add_f32 v167, v167, v47
    v_lshrrev_b32 v2, 3, v0
    v_mul_u32_u24 v2, 272, v2
    v_lshl_add_u32 v2, v3, 5, v2
    ds_write_b128 v2, v[160:163] offset:0
    ds_write_b128 v2, v[164:167] offset:16
    s_waitcnt lgkmcnt(0)
    s_barrier
    v_and_b32 v2, 31, v1
    v_lshlrev_b32 v2, 2, v2
    v_lshrrev_b32 v3, 5, v1
    v_mul_u32_u24 v3, 8704, v3
    v_add_u32 v2, v2, v3
    s_min_u32 s54, s48, 1
    s_lshl_b32 s55, s54, 7
    v_add_u32 v2, s55, v2
    ds_read_b32 v64, v2 offset:0
    ds_read_b32 v65, v2 offset:272
    ds_read_b32 v66, v2 offset:544
    ds_read_b32 v67, v2 offset:816
    ds_read_b32 v68, v2 offset:1088
    ds_read_b32 v69, v2 offset:1360
    ds_read_b32 v70, v2 offset:1632
    ds_read_b32 v71, v2 offset:1904
    ds_read_b32 v72, v2 offset:2176
    ds_read_b32 v73, v2 offset:2448
    ds_read_b32 v74, v2 offset:2720
    ds_read_b32 v75, v2 offset:2992
    ds_read_b32 v76, v2 offset:3264
    ds_read_b32 v77, v2 offset:3536
    ds_read_b32 v78, v2 offset:3808
    ds_read_b32 v79, v2 offset:4080
    ds_read_b32 v80, v2 offset:4352
    ds_read_b32 v81, v2 offset:4624
    ds_read_b32 v82, v2 offset:4896
    ds_read_b32 v83, v2 offset:5168
    ds_read_b32 v84, v2 offset:5440
    ds_read_b32 v85, v2 offset:5712
    ds_read_b32 v86, v2 offset:5984
    ds_read_b32 v87, v2 offset:6256
    ds_read_b32 v88, v2 offset:6528
    ds_read_b32 v89, v2 offset:6800
    ds_read_b32 v90, v2 offset:7072
    ds_read_b32 v91, v2 offset:7344
    ds_read_b32 v92, v2 offset:7616
    ds_read_b32 v93, v2 offset:7888
    ds_read_b32 v94, v2 offset:8160
    ds_read_b32 v95, v2 offset:8432
    s_waitcnt lgkmcnt(0)
    v_add_f32 v64, v64, v80
    v_add_f32 v65, v65, v81
    v_add_f32 v66, v66, v82
    v_add_f32 v67, v67, v83
    v_add_f32 v68, v68, v84
    v_add_f32 v69, v69, v85
    v_add_f32 v70, v70, v86
    v_add_f32 v71, v71, v87
    v_add_f32 v72, v72, v88
    v_add_f32 v73, v73, v89
    v_add_f32 v74, v74, v90
    v_add_f32 v75, v75, v91
    v_add_f32 v76, v76, v92
    v_add_f32 v77, v77, v93
    v_add_f32 v78, v78, v94
    v_add_f32 v79, v79, v95
    v_add_f32 v64, v64, v72
    v_add_f32 v65, v65, v73
    v_add_f32 v66, v66, v74
    v_add_f32 v67, v67, v75
    v_add_f32 v68, v68, v76
    v_add_f32 v69, v69, v77
    v_add_f32 v70, v70, v78
    v_add_f32 v71, v71, v79
    v_add_f32 v64, v64, v68
    v_add_f32 v65, v65, v69
    v_add_f32 v66, v66, v70
    v_add_f32 v67, v67, v71
    v_add_f32 v64, v64, v66
    v_add_f32 v65, v65, v67
    v_add_f32 v64, v64, v65
    v_mov_b32 v65, v64
    s_nop 1
    v_permlane32_swap_b32 v64, v65
    v_add_f32 v64, v64, v65
    v_cvt_pk_bf16_f32 v66, v64, v64
    v_and_b32 v66, 0xffff0000, v66
    v_sub_f32 v64, v64, v66
    v_cvt_pk_bf16_f32 v68, v66, v64
    v_and_b32 v67, 0xffff0000, v68
    v_sub_f32 v64, v64, v67
    v_cvt_pk_bf16_f32 v69, v66, v64
    v_lshlrev_b32 v2, 3, v1
    s_lshl_b32 s54, s54, 8
    s_mul_i32 s55, s56, 1536
    s_add_u32 s54, s54, s55
    s_add_u32 s54, s54, 8781824
    s_mov_b64 exec, 0xffffffff
    buffer_store_dwordx2 v[68:69], v2, s[44:47], s54 offen sc1
    s_mov_b64 exec, -1
    s_and_b32 s100, s49, 1
    s_lshl_b32 s100, s100, 2
    s_lshr_b32 s54, s50, 3
    s_add_u32 s100, s100, s54
    s_lshr_b32 s101, s49, 1
    s_lshl_b32 s101, s101, 3
    s_and_b32 s55, s50, 7
    s_add_u32 s101, s101, s55
    s_lshl_b32 s97, s54, 1
    s_add_u32 s97, s97, s55
    s_and_b32 s3, s49, 1
    s_add_u32 s54, s97, s3
    s_and_b32 s54, s54, 7
    s_mul_i32 s3, s54, 11
    s_lshr_b32 s3, s3, 2
    v_bfe_u32 v2, v1, 4, 1
    v_lshlrev_b32 v2, 2, v2
    v_and_b32 v3, 7, v1
    v_xor_b32 v2, v2, v3
    v_lshlrev_b32 v2, 4, v2
    v_lshrrev_b32 v3, 3, v1
    s_mov_b32 s68, s48
    s_lshl_b32 s69, s68, 10
    v_lshl_add_u32 v60, v3, 12, v2
    s_lshl_b32 s54, s68, 15
    s_lshl_b32 s55, s101, 7
    s_add_u32 s54, s54, s55
    v_add_u32 v60, s54, v60
    v_lshl_add_u32 v62, v3, 10, v2
    s_lshl_b32 s54, s68, 13
    s_lshl_b32 s55, s100, 7
    s_add_u32 s54, s54, s55
    v_add_u32 v62, s54, v62
    s_waitcnt vmcnt(0)
    s_barrier
    s_add_u32 s54, s56, 128
    s_lshl_b32 s54, s54, 7
    s_add_u32 s54, s54, 8519680
    s_cmp_lg_u32 s48, 0
    s_cbranch_scc1 Lw0_31
    v_mov_b32 v2, s52
    v_mov_b32 v3, s53
    v_mov_b32 v4, 0
    s_mov_b64 exec, 1
    buffer_store_dwordx2 v[2:3], v4, s[44:47], s54 offen sc1
    s_mov_b64 exec, -1
Lw0_31:
    v_lshlrev_b32 v10, 7, v1
    v_add_u32 v10, 8552448, v10
    s_mov_b32 s96, 0
    s_mov_b64 exec, 0x1
Lpoll_32:
    buffer_load_dwordx2 v[8:9], v10, s[44:47], 0 offen sc1
    s_waitcnt vmcnt(0)
    v_cmp_ne_u64 vcc, s[52:53], v[8:9]
    s_add_u32 s96, s96, 1
    s_cmp_eq_u64 vcc, 0
    s_cbranch_scc1 Lpd_33
    s_mov_b64 exec, vcc
    s_cmp_gt_u32 s96, 20000
    s_cbranch_scc1 Lpd_33
    s_sleep 1
    s_branch Lpoll_32
Lpd_33:
    s_mov_b64 exec, -1
    s_cmp_lt_u32 s48, 4
    s_cbranch_scc1 Lpe_34
    v_lshrrev_b32 v2, 3, v0
    v_and_b32 v3, 7, v0
    v_lshlrev_b32 v56, 10, v2
    v_lshl_add_u32 v56, v3, 4, v56
    s_lshl_b32 s94, s101, 16
    s_lshl_b32 s54, s100, 7
    s_add_u32 s94, s94, s54
    buffer_load_dwordx4 v[36:39], v56, s[4:7], s94 offen
    v_mul_u32_u24 v57, 272, v2
    v_lshl_add_u32 v57, v3, 5, v57
    v_lshlrev_b32 v2, 1, v2
    s_lshl_b32 s54, s101, 7
    buffer_load_ushort v52, v2, s[32:35], s54 offen
    v_mov_b32 v53, 0xbfb8aa3b
    v_bfe_u32 v2, v1, 4, 1
    v_lshlrev_b32 v2, 2, v2
    v_and_b32 v3, 7, v1
    v_xor_b32 v2, v2, v3
    v_lshlrev_b32 v2, 4, v2
    v_lshrrev_b32 v3, 3, v1
    s_and_b32 s68, s48, 3
    s_lshl_b32 s68, s68, 1
    s_lshl_b32 s69, s68, 10
    v_lshl_add_u32 v60, v3, 12, v2
    s_lshl_b32 s54, s68, 15
    s_lshl_b32 s55, s101, 7
    s_add_u32 s54, s54, s55
    v_add_u32 v60, s54, v60
    v_lshl_add_u32 v62, v3, 10, v2
    s_lshl_b32 s54, s68, 13
    s_lshl_b32 s55, s100, 7
    s_add_u32 s54, s54, s55
    v_add_u32 v62, s54, v62
    v_add_u32 v61, 0x8000, v60
    v_add_u32 v63, 0x2000, v62
    v_and_b32 v3, 7, v1
    s_lshr_b32 s54, s101, 1
    s_lshl_b32 s54, s54, 3
    v_add_u32 v3, s54, v3
    v_lshlrev_b32 v3, 7, v3
    v_add_u32 v59, 8568832, v3
    v_min_u32 v2, 14, v1
    s_mul_i32 s54, s100, 15
    v_add_u32 v2, s54, v2
    v_lshlrev_b32 v2, 7, v2
    v_add_u32 v58, 8585216, v2
    s_bfe_u32 s55, s48, 0x10001
    s_and_b32 s68, s48, 1
    s_lshl_b32 s68, s68, 11
    s_lshl_b32 s93, s100, 1
    s_add_u32 s93, s93, s55
    s_mul_i32 s93, s93, 92160
    s_add_u32 s93, s93, s68
    s_add_u32 s93, s93, 6291456
    s_and_b32 s68, s48, 1
    s_lshl_b32 s92, s101, 1
    s_add_u32 s92, s92, s68
    s_lshl_b32 s92, s92, 15
    s_lshl_b32 s54, s55, 11
    s_add_u32 s92, s92, s54
    s_add_u32 s92, s92, 4194304
    v_bfe_u32 v2, v1, 2, 2
    v_lshrrev_b32 v3, 5, v1
    v_lshl_add_u32 v28, v3, 2, v2
    v_lshlrev_b32 v28, 7, v28
    v_lshrrev_b32 v2, 1, v2
    v_lshl_add_u32 v28, v2, 6, v28
    v_bfe_u32 v2, v1, 4, 1
    v_lshl_add_u32 v28, v2, 5, v28
    v_and_b32 v2, 3, v1
    v_lshl_add_u32 v28, v2, 3, v28
    s_lshl_b32 s54, s55, 12
    v_add_u32 v28, s54, v28
    v_xor_b32 v29, 64, v28
    v_add_u32 v30, 0x10000, v28
    v_add_u32 v31, 0x10000, v29
    v_and_b32 v2, 31, v1
    v_mul_u32_u24 v2, 272, v2
    v_lshl_add_u32 v54, v3, 4, v2
    s_mul_i32 s54, s55, 17408
    v_add_u32 v54, s54, v54
    s_mul_i32 s54, s68, 8704
    v_add_u32 v54, s54, v54
    s_lshl_b32 s70, s3, 12
    s_add_u32 s70, s70, s93
    s_add_u32 s68, s93, 90112
    s_add_u32 s71, s70, 4096
    s_cmp_ge_u32 s71, s68
    s_cselect_b32 s71, s93, s71
    s_add_u32 s72, s71, 4096
    s_cmp_ge_u32 s72, s68
    s_cselect_b32 s72, s93, s72
    s_add_u32 s73, s72, 4096
    s_cmp_ge_u32 s73, s68
    s_cselect_b32 s73, s93, s73
    s_add_u32 s74, s73, 4096
    s_cmp_ge_u32 s74, s68
    s_cselect_b32 s74, s93, s74
    s_add_u32 s75, s74, 4096
    s_cmp_ge_u32 s75, s68
    s_cselect_b32 s75, s93, s75
    s_add_u32 s76, s75, 4096
    s_cmp_ge_u32 s76, s68
    s_cselect_b32 s76, s93, s76
    s_add_u32 s77, s76, 4096
    s_cmp_ge_u32 s77, s68
    s_cselect_b32 s77, s93, s77
    s_add_u32 s78, s77, 4096
    s_cmp_ge_u32 s78, s68
    s_cselect_b32 s78, s93, s78
    s_add_u32 s79, s78, 4096
    s_cmp_ge_u32 s79, s68
    s_cselect_b32 s79, s93, s79
    s_add_u32 s80, s79, 4096
    s_cmp_ge_u32 s80, s68
    s_cselect_b32 s80, s93, s80
    s_add_u32 s81, s80, 4096
    s_cmp_ge_u32 s81, s68
    s_cselect_b32 s81, s93, s81
    s_add_u32 s82, s81, 4096
    s_cmp_ge_u32 s82, s68
    s_cselect_b32 s82, s93, s82
    s_add_u32 s83, s82, 4096
    s_cmp_ge_u32 s83, s68
    s_cselect_b32 s83, s93, s83
    s_add_u32 s84, s83, 4096
    s_cmp_ge_u32 s84, s68
    s_cselect_b32 s84, s93, s84
    s_add_u32 s85, s84, 4096
    s_cmp_ge_u32 s85, s68
    s_cselect_b32 s85, s93, s85
    s_add_u32 s86, s85, 4096
    s_cmp_ge_u32 s86, s68
    s_cselect_b32 s86, s93, s86
    s_add_u32 s87, s86, 4096
    s_cmp_ge_u32 s87, s68
    s_cselect_b32 s87, s93, s87
    s_add_u32 s88, s87, 4096
    s_cmp_ge_u32 s88, s68
    s_cselect_b32 s88, s93, s88
    s_add_u32 s89, s88, 4096
    s_cmp_ge_u32 s89, s68
    s_cselect_b32 s89, s93, s89
    s_add_u32 s90, s89, 4096
    s_cmp_ge_u32 s90, s68
    s_cselect_b32 s90, s93, s90
    s_add_u32 s91, s90, 4096
    s_cmp_ge_u32 s91, s68
    s_cselect_b32 s91, s93, s91
    s_add_u32 s68, s97, 0
    s_and_b32 s68, s68, 7
    s_lshl_b32 s68, s68, 16
    s_add_u32 m0, s69, 32768
    s_nop 0
    buffer_load_dwordx4 v62, s[16:19], s68 offen lds
    s_add_u32 m0, s69, 33792
    s_nop 0
    buffer_load_dwordx4 v63, s[16:19], s68 offen lds
    s_add_u32 s68, s97, 1
    s_and_b32 s68, s68, 7
    s_lshl_b32 s68, s68, 16
    s_add_u32 m0, s69, 40960
    s_nop 0
    buffer_load_dwordx4 v62, s[16:19], s68 offen lds
    s_add_u32 m0, s69, 41984
    s_nop 0
    buffer_load_dwordx4 v63, s[16:19], s68 offen lds
    s_add_u32 s68, s97, 2
    s_and_b32 s68, s68, 7
    s_lshl_b32 s68, s68, 16
    s_add_u32 m0, s69, 49152
    s_nop 0
    buffer_load_dwordx4 v62, s[16:19], s68 offen lds
    s_add_u32 m0, s69, 50176
    s_nop 0
    buffer_load_dwordx4 v63, s[16:19], s68 offen lds
    s_add_u32 s68, s97, 3
    s_and_b32 s68, s68, 7
    s_lshl_b32 s68, s68, 16
    s_add_u32 m0, s69, 57344
    s_nop 0
    buffer_load_dwordx4 v62, s[16:19], s68 offen lds
    s_add_u32 m0, s69, 58368
    s_nop 0
    buffer_load_dwordx4 v63, s[16:19], s68 offen lds
    s_add_u32 s68, s97, 4
    s_and_b32 s68, s68, 7
    s_lshl_b32 s68, s68, 16
    s_add_u32 m0, s69, 65536
    s_nop 0
    buffer_load_dwordx4 v62, s[16:19], s68 offen lds
    s_add_u32 m0, s69, 66560
    s_nop 0
    buffer_load_dwordx4 v63, s[16:19], s68 offen lds
    s_add_u32 s68, s97, 5
    s_and_b32 s68, s68, 7
    s_lshl_b32 s68, s68, 16
    s_add_u32 m0, s69, 73728
    s_nop 0
    buffer_load_dwordx4 v62, s[16:19], s68 offen lds
    s_add_u32 m0, s69, 74752
    s_nop 0
    buffer_load_dwordx4 v63, s[16:19], s68 offen lds
    s_add_u32 s68, s97, 6
    s_and_b32 s68, s68, 7
    s_lshl_b32 s68, s68, 16
    s_add_u32 m0, s69, 81920
    s_nop 0
    buffer_load_dwordx4 v62, s[16:19], s68 offen lds
    s_add_u32 m0, s69, 82944
    s_nop 0
    buffer_load_dwordx4 v63, s[16:19], s68 offen lds
    s_add_u32 s68, s97, 7
    s_and_b32 s68, s68, 7
    s_lshl_b32 s68, s68, 16
    s_add_u32 m0, s69, 90112
    s_nop 0
    buffer_load_dwordx4 v62, s[16:19], s68 offen lds
    s_add_u32 m0, s69, 91136
    s_nop 0
    buffer_load_dwordx4 v63, s[16:19], s68 offen lds
    s_add_u32 s68, s3, 0
    s_cmp_ge_u32 s68, 22
    s_cselect_b32 s54, 22, 0
    s_sub_u32 s68, s68, s54
    s_lshl_b32 s68, s68, 18
    s_add_u32 m0, s69, 98304
    s_nop 0
    buffer_load_dwordx4 v60, s[28:31], s68 offen lds
    s_add_u32 m0, s69, 99328
    s_nop 0
    buffer_load_dwordx4 v61, s[28:31], s68 offen lds
    s_add_u32 s68, s3, 1
    s_cmp_ge_u32 s68, 22
    s_cselect_b32 s54, 22, 0
    s_sub_u32 s68, s68, s54
    s_lshl_b32 s68, s68, 18
    s_add_u32 m0, s69, 106496
    s_nop 0
    buffer_load_dwordx4 v60, s[28:31], s68 offen lds
    s_add_u32 m0, s69, 107520
    s_nop 0
    buffer_load_dwordx4 v61, s[28:31], s68 offen lds
    s_add_u32 s68, s3, 2
    s_cmp_ge_u32 s68, 22
    s_cselect_b32 s54, 22, 0
    s_sub_u32 s68, s68, s54
    s_lshl_b32 s68, s68, 18
    s_add_u32 m0, s69, 114688
    s_nop 0
    buffer_load_dwordx4 v60, s[28:31], s68 offen lds
    s_add_u32 m0, s69, 115712
    s_nop 0
    buffer_load_dwordx4 v61, s[28:31], s68 offen lds
    s_add_u32 s68, s3, 3
    s_cmp_ge_u32 s68, 22
    s_cselect_b32 s54, 22, 0
    s_sub_u32 s68, s68, s54
    s_lshl_b32 s68, s68, 18
    s_add_u32 m0, s69, 122880
    s_nop 0
    buffer_load_dwordx4 v60, s[28:31], s68 offen lds
    s_add_u32 m0, s69, 123904
    s_nop 0
    buffer_load_dwordx4 v61, s[28:31], s68 offen lds
    s_add_u32 s68, s3, 4
    s_cmp_ge_u32 s68, 22
    s_cselect_b32 s54, 22, 0
    s_sub_u32 s68, s68, s54
    s_lshl_b32 s68, s68, 18
    s_add_u32 m0, s69, 16384
    s_nop 0
    buffer_load_dwordx4 v60, s[28:31], s68 offen lds
    s_add_u32 m0, s69, 17408
    s_nop 0
    buffer_load_dwordx4 v61, s[28:31], s68 offen lds
    s_add_u32 s68, s3, 5
    s_cmp_ge_u32 s68, 22
    s_cselect_b32 s54, 22, 0
    s_sub_u32 s68, s68, s54
    s_lshl_b32 s68, s68, 18
    s_add_u32 m0, s69, 24576
    s_nop 0
    buffer_load_dwordx4 v60, s[28:31], s68 offen lds
    s_add_u32 m0, s69, 25600
    s_nop 0
    buffer_load_dwordx4 v61, s[28:31], s68 offen lds
    s_branch L_pload
Lpe_34:
    v_lshrrev_b32 v2, 3, v0
    v_and_b32 v3, 7, v0
    v_lshlrev_b32 v56, 10, v2
    v_lshl_add_u32 v56, v3, 4, v56
    s_lshl_b32 s94, s101, 16
    s_lshl_b32 s54, s100, 7
    s_add_u32 s94, s94, s54
    buffer_load_dwordx4 v[36:39], v56, s[4:7], s94 offen
    v_mul_u32_u24 v57, 272, v2
    v_lshl_add_u32 v57, v3, 5, v57
    v_lshlrev_b32 v2, 1, v2
    s_lshl_b32 s54, s101, 7
    buffer_load_ushort v52, v2, s[32:35], s54 offen
    v_mov_b32 v53, 0xbfb8aa3b
    s_lshr_b32 s68, s48, 1
    s_and_b32 s69, s48, 1
    v_bfe_u32 v2, v1, 2, 2
    v_lshrrev_b32 v3, 5, v1
    v_lshl_add_u32 v28, v3, 2, v2
    v_lshlrev_b32 v28, 7, v28
    v_lshrrev_b32 v2, 1, v2
    v_lshl_add_u32 v28, v2, 6, v28
    v_bfe_u32 v2, v1, 4, 1
    v_lshl_add_u32 v28, v2, 5, v28
    v_and_b32 v2, 3, v1
    v_lshl_add_u32 v28, v2, 3, v28
    s_lshl_b32 s54, s68, 12
    v_add_u32 v28, s54, v28
    v_xor_b32 v29, 64, v28
    v_add_u32 v30, 0x10000, v28
    v_add_u32 v31, 0x10000, v29
    v_and_b32 v2, 31, v1
    v_mul_u32_u24 v2, 272, v2
    v_lshl_add_u32 v54, v3, 4, v2
    s_mul_i32 s54, s68, 17408
    v_add_u32 v54, s54, v54
    s_mul_i32 s54, s69, 8704
    v_add_u32 v54, s54, v54
    s_lshl_b32 s54, s69, 6
    v_xor_b32 v32, s54, v28
    v_add_u32 v33, 0x10000, v32
    v_add_u32 v34, 0x20000, v32
    s_lshl_b32 s54, s68, 11
    v_add_u32 v58, s54, v6
    v_add_u32 v59, 0x10000, v58
    s_branch L_pcons
L_roleA:
    s_lshr_b32 s56, s62, 3
    s_and_b32 s57, s62, 7
    s_add_u32 s51, s56, s57
    s_lshl_b32 s51, s51, 1
    s_and_b32 s54, s49, 1
    s_add_u32 s51, s51, s54
    s_and_b32 s58, s48, 3
    s_lshr_b32 s59, s48, 2
    v_lshrrev_b32 v2, 3, v1
    v_and_b32 v3, 7, v1
    v_lshrrev_b32 v5, 4, v1
    v_xor_b32 v5, v5, v3
    v_lshlrev_b32 v8, 10, v2
    v_lshl_add_u32 v8, v5, 4, v8
    s_lshl_b32 s54, s56, 17
    s_lshl_b32 s55, s48, 14
    s_add_u32 s54, s54, s55
    v_add_u32 v8, s54, v8
    v_xor_b32 v9, 64, v8
    v_add_u32 v9, 0x2000, v9
    v_mul_u32_u24 v5, 3072, v2
    v_bfe_u32 v2, v1, 4, 1
    v_lshlrev_b32 v2, 2, v2
    v_xor_b32 v2, v2, v3
    v_lshl_add_u32 v5, v2, 4, v5
    s_lshl_b32 s55, s57, 7
    s_mul_i32 s54, s48, 24576
    s_add_u32 s55, s55, s54
    v_add_u32 v5, s55, v5
    v_add_u32 v10, 1024, v5
    v_add_u32 v11, 2048, v5
    s_lshl_b32 s64, s48, 11
    s_lshl_b32 s67, s48, 10
    s_add_u32 s65, s51, 0
    s_and_b32 s65, s65, 7
    s_lshl_b32 s70, s65, 7
    s_mul_i32 s78, s65, 196608
    s_add_u32 s65, s51, 1
    s_and_b32 s65, s65, 7
    s_lshl_b32 s71, s65, 7
    s_mul_i32 s79, s65, 196608
    s_add_u32 m0, s64, 0
    s_nop 0
    buffer_load_dwordx4 v8, s[4:7], s70 offen lds
    s_add_u32 m0, s67, 65536
    s_nop 0
    buffer_load_dwordx4 v10, s[8:11], s78 offen lds
    s_add_u32 m0, s64, 1024
    s_nop 0
    buffer_load_dwordx4 v9, s[4:7], s70 offen lds
    s_add_u32 m0, s67, 73728
    s_nop 0
    buffer_load_dwordx4 v11, s[8:11], s78 offen lds
    s_add_u32 m0, s64, 16384
    s_nop 0
    buffer_load_dwordx4 v8, s[4:7], s71 offen lds
    s_add_u32 m0, s67, 81920
    s_nop 0
    buffer_load_dwordx4 v10, s[8:11], s79 offen lds
    s_add_u32 m0, s64, 17408
    s_nop 0
    buffer_load_dwordx4 v9, s[4:7], s71 offen lds
    s_add_u32 m0, s67, 90112
    s_nop 0
    buffer_load_dwordx4 v11, s[8:11], s79 offen lds
    s_add_u32 s65, s51, 2
    s_and_b32 s65, s65, 7
    s_lshl_b32 s72, s65, 7
    s_mul_i32 s80, s65, 196608
    s_add_u32 s65, s51, 3
    s_and_b32 s65, s65, 7
    s_lshl_b32 s73, s65, 7
    s_mul_i32 s81, s65, 196608
    s_add_u32 s65, s51, 4
    s_and_b32 s65, s65, 7
    s_lshl_b32 s74, s65, 7
    s_mul_i32 s82, s65, 196608
    s_add_u32 s65, s51, 5
    s_and_b32 s65, s65, 7
    s_lshl_b32 s75, s65, 7
    s_mul_i32 s83, s65, 196608
    s_add_u32 s65, s51, 6
    s_and_b32 s65, s65, 7
    s_lshl_b32 s76, s65, 7
    s_mul_i32 s84, s65, 196608
    s_add_u32 s65, s51, 7
    s_and_b32 s65, s65, 7
    s_lshl_b32 s77, s65, 7
    s_mul_i32 s85, s65, 196608
    s_lshl_b32 s61, s62, 7
    s_add_u32 s63, s61, 8552448
    s_add_u32 s61, s61, 8568832
    v_lshrrev_b32 v3, 5, v1
    v_bfe_u32 v2, v1, 4, 1
    v_lshlrev_b32 v2, 9, v2
    v_and_b32 v4, 15, v1
    v_lshl_add_u32 v2, v4, 1, v2
    v_lshl_add_u32 v2, v3, 7, v2
    s_lshl_b32 s54, s57, 11
    s_lshl_b32 s55, s59, 10
    s_add_u32 s54, s54, s55
    buffer_load_ushort v248, v2, s[12:15], s54 offen offset:0
    buffer_load_ushort v249, v2, s[12:15], s54 offen offset:32
    buffer_load_ushort v250, v2, s[12:15], s54 offen offset:64
    buffer_load_ushort v251, v2, s[12:15], s54 offen offset:96
    buffer_load_ushort v252, v2, s[12:15], s54 offen offset:256
    buffer_load_ushort v253, v2, s[12:15], s54 offen offset:288
    buffer_load_ushort v254, v2, s[12:15], s54 offen offset:320
    buffer_load_ushort v255, v2, s[12:15], s54 offen offset:352
    s_mov_b32 s89, 0x3f803f80
    v_bfe_u32 v2, v1, 2, 2
    v_lshl_add_u32 v4, v3, 3, v2
    v_lshlrev_b32 v16, 7, v4
    v_lshrrev_b32 v2, 1, v2
    v_xor_b32 v2, s59, v2
    v_lshl_add_u32 v16, v2, 6, v16
    v_bfe_u32 v2, v1, 4, 1
    v_lshl_add_u32 v16, v2, 5, v16
    v_and_b32 v2, 3, v1
    v_lshl_add_u32 v16, v2, 3, v16
    v_add_u32 v17, 0x10000, v16
    v_and_b32 v2, 31, v1
    v_lshlrev_b32 v2, 7, v2
    s_lshl_b32 s54, s58, 12
    v_add_u32 v2, s54, v2
    v_bfe_u32 v4, v1, 1, 3
    v_xor_b32 v4, v4, v3
    v_xor_b32 v20, 0, v4
    v_lshl_add_u32 v12, v20, 4, v2
    v_xor_b32 v20, 2, v4
    v_lshl_add_u32 v13, v20, 4, v2
    v_xor_b32 v20, 4, v4
    v_lshl_add_u32 v14, v20, 4, v2
    v_xor_b32 v20, 6, v4
    v_lshl_add_u32 v15, v20, 4, v2
    v_mov_b32 v30, 0
    v_mov_b32 v31, 0
    s_lshl_b32 s54, s58, 11
    v_add_u32 v19, s54, v17
    v_and_b32 v2, 16, v1
    v_cmp_eq_u32 vcc, 0, v2
    v_mov_b32 v2, s89
    s_nop 0
    v_cndmask_b32 v56, v30, v2, vcc
    v_cndmask_b32 v60, v2, v30, vcc
    v_cndmask_b32 v57, v30, v2, vcc
    v_cndmask_b32 v61, v2, v30, vcc
    v_cndmask_b32 v58, v30, v2, vcc
    v_cndmask_b32 v62, v2, v30, vcc
    v_cndmask_b32 v59, v30, v2, vcc
    v_cndmask_b32 v63, v2, v30, vcc
    s_lshl_b32 s54, s59, 10
    s_add_u32 s54, s54, 149504
    v_and_b32 v21, 31, v1
    v_lshlrev_b32 v21, 4, v21
    v_add_u32 v21, s54, v21
    s_lshl_b32 s55, s58, 2
    s_add_u32 s54, s54, s55
    v_add_u32 v20, s54, v6
    v_mov_b32 v2, 163832
    ds_write_b64 v2, v[30:31]
    s_mul_i32 s87, s57, 1536
    s_lshl_b32 s54, s59, 8
    s_add_u32 s87, s87, s54
    s_add_u32 s87, s87, 8781824
    v_and_b32 v2, 1, v1
    s_lshl_b32 s54, s56, 3
    s_lshl_b32 s55, s58, 1
    s_add_u32 s54, s54, s55
    v_add_u32 v2, s54, v2
    s_lshl_b32 s60, s54, 7
    s_add_u32 s60, s60, 8650752
    v_lshlrev_b32 v18, 7, v2
    v_add_u32 v18, 8519680, v18
    s_and_b32 s100, s49, 1
    s_lshl_b32 s100, s100, 2
    s_lshr_b32 s54, s50, 3
    s_add_u32 s100, s100, s54
    s_lshr_b32 s101, s49, 1
    s_lshl_b32 s101, s101, 3
    s_and_b32 s55, s50, 7
    s_add_u32 s101, s101, s55
    s_lshl_b32 s97, s54, 1
    s_add_u32 s97, s97, s55
    s_and_b32 s3, s49, 1
    s_add_u32 s54, s97, s3
    s_and_b32 s54, s54, 7
    s_mul_i32 s3, s54, 11
    s_lshr_b32 s3, s3, 2
    s_add_u32 m0, s64, 32768
    s_nop 0
    buffer_load_dwordx4 v8, s[4:7], s72 offen lds
    s_add_u32 m0, s67, 98304
    s_nop 0
    buffer_load_dwordx4 v10, s[8:11], s80 offen lds
    s_add_u32 m0, s64, 33792
    s_nop 0
    buffer_load_dwordx4 v9, s[4:7], s72 offen lds
    s_add_u32 m0, s67, 106496
    s_nop 0
    buffer_load_dwordx4 v11, s[8:11], s80 offen lds
    s_waitcnt lgkmcnt(0)
    s_waitcnt vmcnt(12)
    s_barrier
    ds_read_b128 v[128:131], v12 offset:0
    ds_read_b64_tr_b16 v[112:113], v17 offset:0
    ds_read_b64_tr_b16 v[114:115], v17 offset:512
    ds_read_b64_tr_b16 v[40:41], v17 offset:8192
    ds_read_b64_tr_b16 v[42:43], v17 offset:8704
    ds_read_b128 v[132:135], v13 offset:0
    ds_read_b64_tr_b16 v[116:117], v17 offset:2048
    ds_read_b64_tr_b16 v[118:119], v17 offset:2560
    ds_read_b64_tr_b16 v[44:45], v17 offset:10240
    ds_read_b64_tr_b16 v[46:47], v17 offset:10752
    v_mul_u32_u24 v2, 3072, v1
    s_and_b32 s54, s56, 3
    s_lshl_b32 s54, s54, 3
    s_add_u32 s54, s54, s48
    s_mul_i32 s54, s54, 49152
    s_lshl_b32 s55, s57, 7
    s_add_u32 s54, s54, s55
    s_mov_b64 exec, 0xffff
    buffer_load_dword v247, v2, s[8:11], s54 offen
    s_mov_b64 exec, -1
    ds_read_b64_tr_b16 v[32:33], v19 offset:0
    ds_read_b64_tr_b16 v[34:35], v19 offset:512
    ds_read_b64_tr_b16 v[36:37], v19 offset:8192
    ds_read_b64_tr_b16 v[38:39], v19 offset:8704
    s_waitcnt lgkmcnt(9)
    v_mfma_f32_32x32x16_bf16 v[64:79], v[112:115], v[128:131], 0
    ds_read_b128 v[136:139], v14 offset:0
    ds_read_b64_tr_b16 v[120:121], v17 offset:4096
    ds_read_b64_tr_b16 v[122:123], v17 offset:4608
    v_mfma_f32_32x32x16_bf16 v[80:95], v[40:43], v[128:131], 0
    ds_read_b64_tr_b16 v[48:49], v17 offset:12288
    ds_read_b64_tr_b16 v[50:51], v17 offset:12800
    s_add_u32 m0, s64, 49152
    s_nop 0
    buffer_load_dwordx4 v8, s[4:7], s73 offen lds
    s_waitcnt lgkmcnt(9)
    v_mfma_f32_32x32x16_bf16 v[64:79], v[116:119], v[132:135], v[64:79]
    ds_read_b128 v[140:143], v15 offset:0
    ds_read_b64_tr_b16 v[124:125], v17 offset:6144
    ds_read_b64_tr_b16 v[126:127], v17 offset:6656
    s_waitcnt lgkmcnt(8)
    v_mfma_f32_32x32x16_bf16 v[96:111], v[56:59], v[32:35], 0
    v_mfma_f32_32x32x16_bf16 v[80:95], v[44:47], v[132:135], v[80:95]
    ds_read_b64_tr_b16 v[52:53], v17 offset:14336
    ds_read_b64_tr_b16 v[54:55], v17 offset:14848
    s_add_u32 m0, s67, 114688
    s_nop 0
    buffer_load_dwordx4 v10, s[8:11], s81 offen lds
    s_waitcnt lgkmcnt(5)
    v_mfma_f32_32x32x16_bf16 v[64:79], v[120:123], v[136:139], v[64:79]
    ds_read_b128 v[144:147], v12 offset:16384
    ds_read_b64_tr_b16 v[112:113], v17 offset:16384
    ds_read_b64_tr_b16 v[114:115], v17 offset:16896
    v_mfma_f32_32x32x16_bf16 v[80:95], v[48:51], v[136:139], v[80:95]
    ds_read_b64_tr_b16 v[40:41], v17 offset:24576
    ds_read_b64_tr_b16 v[42:43], v17 offset:25088
    s_add_u32 m0, s64, 50176
    s_nop 0
    buffer_load_dwordx4 v9, s[4:7], s73 offen lds
    v_mfma_f32_32x32x16_bf16 v[96:111], v[60:63], v[36:39], v[96:111]
    s_waitcnt lgkmcnt(5)
    v_mfma_f32_32x32x16_bf16 v[64:79], v[124:127], v[140:143], v[64:79]
    ds_read_b128 v[148:151], v13 offset:16384
    ds_read_b64_tr_b16 v[116:117], v17 offset:18432
    ds_read_b64_tr_b16 v[118:119], v17 offset:18944
    v_mfma_f32_32x32x16_bf16 v[80:95], v[52:55], v[140:143], v[80:95]
    ds_read_b64_tr_b16 v[44:45], v17 offset:26624
    ds_read_b64_tr_b16 v[46:47], v17 offset:27136
    s_add_u32 m0, s67, 122880
    s_nop 0
    buffer_load_dwordx4 v11, s[8:11], s81 offen lds
    s_waitcnt vmcnt(5)
    s_barrier
    v_lshl_or_b32 v24, v249, 16, v248
    v_lshl_or_b32 v25, v251, 16, v250
    v_lshl_or_b32 v26, v253, 16, v252
    v_lshl_or_b32 v27, v255, 16, v254
    ds_read_b64_tr_b16 v[32:33], v19 offset:16384
    ds_read_b64_tr_b16 v[34:35], v19 offset:16896
    ds_read_b64_tr_b16 v[36:37], v19 offset:24576
    ds_read_b64_tr_b16 v[38:39], v19 offset:25088
    s_waitcnt lgkmcnt(9)
    v_mfma_f32_32x32x16_bf16 v[64:79], v[112:115], v[144:147], v[64:79]
    ds_read_b128 v[152:155], v14 offset:16384
    ds_read_b64_tr_b16 v[120:121], v17 offset:20480
    ds_read_b64_tr_b16 v[122:123], v17 offset:20992
    v_mfma_f32_32x32x16_bf16 v[80:95], v[40:43], v[144:147], v[80:95]
    ds_read_b64_tr_b16 v[48:49], v17 offset:28672
    ds_read_b64_tr_b16 v[50:51], v17 offset:29184
    s_add_u32 m0, s64, 0
    s_nop 0
    buffer_load_dwordx4 v8, s[4:7], s74 offen lds
    s_waitcnt lgkmcnt(9)
    v_mfma_f32_32x32x16_bf16 v[64:79], v[116:119], v[148:151], v[64:79]
    ds_read_b128 v[156:159], v15 offset:16384
    ds_read_b64_tr_b16 v[124:125], v17 offset:22528
    ds_read_b64_tr_b16 v[126:127], v17 offset:23040
    s_waitcnt lgkmcnt(8)
    v_mfma_f32_32x32x16_bf16 v[96:111], v[56:59], v[32:35], v[96:111]
    v_mfma_f32_32x32x16_bf16 v[80:95], v[44:47], v[148:151], v[80:95]
    ds_read_b64_tr_b16 v[52:53], v17 offset:30720
    ds_read_b64_tr_b16 v[54:55], v17 offset:31232
    s_add_u32 m0, s67, 65536
    s_nop 0
    buffer_load_dwordx4 v10, s[8:11], s82 offen lds
    s_waitcnt lgkmcnt(5)
    v_mfma_f32_32x32x16_bf16 v[64:79], v[120:123], v[152:155], v[64:79]
    ds_read_b128 v[160:163], v12 offset:32768
    ds_read_b64_tr_b16 v[112:113], v17 offset:32768
    ds_read_b64_tr_b16 v[114:115], v17 offset:33280
    v_mfma_f32_32x32x16_bf16 v[80:95], v[48:51], v[152:155], v[80:95]
    ds_read_b64_tr_b16 v[40:41], v17 offset:40960
    ds_read_b64_tr_b16 v[42:43], v17 offset:41472
    s_add_u32 m0, s64, 1024
    s_nop 0
    buffer_load_dwordx4 v9, s[4:7], s74 offen lds
    v_mfma_f32_32x32x16_bf16 v[96:111], v[60:63], v[36:39], v[96:111]
    s_waitcnt lgkmcnt(5)
    v_mfma_f32_32x32x16_bf16 v[64:79], v[124:127], v[156:159], v[64:79]
    ds_read_b128 v[164:167], v13 offset:32768
    ds_read_b64_tr_b16 v[116:117], v17 offset:34816
    ds_read_b64_tr_b16 v[118:119], v17 offset:35328
    v_mfma_f32_32x32x16_bf16 v[80:95], v[52:55], v[156:159], v[80:95]
    ds_read_b64_tr_b16 v[44:45], v17 offset:43008
    ds_read_b64_tr_b16 v[46:47], v17 offset:43520
    s_add_u32 m0, s67, 73728
    s_nop 0
    buffer_load_dwordx4 v11, s[8:11], s82 offen lds
    s_waitcnt vmcnt(4)
    s_barrier
    ds_read_b64_tr_b16 v[32:33], v19 offset:32768
    ds_read_b64_tr_b16 v[34:35], v19 offset:33280
    ds_read_b64_tr_b16 v[36:37], v19 offset:40960
    ds_read_b64_tr_b16 v[38:39], v19 offset:41472
    s_waitcnt lgkmcnt(9)
    v_mfma_f32_32x32x16_bf16 v[64:79], v[112:115], v[160:163], v[64:79]
    ds_read_b128 v[168:171], v14 offset:32768
    ds_read_b64_tr_b16 v[120:121], v17 offset:36864
    ds_read_b64_tr_b16 v[122:123], v17 offset:37376
    v_mfma_f32_32x32x16_bf16 v[80:95], v[40:43], v[160:163], v[80:95]
    ds_read_b64_tr_b16 v[48:49], v17 offset:45056
    ds_read_b64_tr_b16 v[50:51], v17 offset:45568
    s_add_u32 m0, s64, 16384
    s_nop 0
    buffer_load_dwordx4 v8, s[4:7], s75 offen lds
    s_waitcnt lgkmcnt(9)
    v_mfma_f32_32x32x16_bf16 v[64:79], v[116:119], v[164:167], v[64:79]
    ds_read_b128 v[172:175], v15 offset:32768
    ds_read_b64_tr_b16 v[124:125], v17 offset:38912
    ds_read_b64_tr_b16 v[126:127], v17 offset:39424
    s_waitcnt lgkmcnt(8)
    v_mfma_f32_32x32x16_bf16 v[96:111], v[56:59], v[32:35], v[96:111]
    v_mfma_f32_32x32x16_bf16 v[80:95], v[44:47], v[164:167], v[80:95]
    ds_read_b64_tr_b16 v[52:53], v17 offset:47104
    ds_read_b64_tr_b16 v[54:55], v17 offset:47616
    s_add_u32 m0, s67, 81920
    s_nop 0
    buffer_load_dwordx4 v10, s[8:11], s83 offen lds
    s_waitcnt lgkmcnt(5)
    v_mfma_f32_32x32x16_bf16 v[64:79], v[120:123], v[168:171], v[64:79]
    ds_read_b128 v[176:179], v12 offset:49152
    ds_read_b64_tr_b16 v[112:113], v17 offset:49152
    ds_read_b64_tr_b16 v[114:115], v17 offset:49664
    v_mfma_f32_32x32x16_bf16 v[80:95], v[48:51], v[168:171], v[80:95]
    ds_read_b64_tr_b16 v[40:41], v17 offset:57344
    ds_read_b64_tr_b16 v[42:43], v17 offset:57856
    s_add_u32 m0, s64, 17408
    s_nop 0
    buffer_load_dwordx4 v9, s[4:7], s75 offen lds
    v_mfma_f32_32x32x16_bf16 v[96:111], v[60:63], v[36:39], v[96:111]
    s_waitcnt lgkmcnt(5)
    v_mfma_f32_32x32x16_bf16 v[64:79], v[124:127], v[172:175], v[64:79]
    ds_read_b128 v[180:183], v13 offset:49152
    ds_read_b64_tr_b16 v[116:117], v17 offset:51200
    ds_read_b64_tr_b16 v[118:119], v17 offset:51712
    v_mfma_f32_32x32x16_bf16 v[80:95], v[52:55], v[172:175], v[80:95]
    ds_read_b64_tr_b16 v[44:45], v17 offset:59392
    ds_read_b64_tr_b16 v[46:47], v17 offset:59904
    s_add_u32 m0, s67, 90112
    s_nop 0
    buffer_load_dwordx4 v11, s[8:11], s83 offen lds
    s_waitcnt vmcnt(4)
    s_barrier
    ds_read_b64_tr_b16 v[32:33], v19 offset:49152
    ds_read_b64_tr_b16 v[34:35], v19 offset:49664
    ds_read_b64_tr_b16 v[36:37], v19 offset:57344
    ds_read_b64_tr_b16 v[38:39], v19 offset:57856
    v_mov_b32 v4, 0
    buffer_load_dwordx2 v[22:23], v4, s[40:43], 0 offen sc1
    s_waitcnt lgkmcnt(9)
    v_mfma_f32_32x32x16_bf16 v[64:79], v[112:115], v[176:179], v[64:79]
    ds_read_b128 v[184:187], v14 offset:49152
    ds_read_b64_tr_b16 v[120:121], v17 offset:53248
    ds_read_b64_tr_b16 v[122:123], v17 offset:53760
    v_mfma_f32_32x32x16_bf16 v[80:95], v[40:43], v[176:179], v[80:95]
    ds_read_b64_tr_b16 v[48:49], v17 offset:61440
    ds_read_b64_tr_b16 v[50:51], v17 offset:61952
    s_add_u32 m0, s64, 32768
    s_nop 0
    buffer_load_dwordx4 v8, s[4:7], s76 offen lds
    s_waitcnt lgkmcnt(9)
    v_mfma_f32_32x32x16_bf16 v[64:79], v[116:119], v[180:183], v[64:79]
    ds_read_b128 v[188:191], v15 offset:49152
    ds_read_b64_tr_b16 v[124:125], v17 offset:55296
    ds_read_b64_tr_b16 v[126:127], v17 offset:55808
    s_waitcnt lgkmcnt(8)
    v_mfma_f32_32x32x16_bf16 v[96:111], v[56:59], v[32:35], v[96:111]
    v_mfma_f32_32x32x16_bf16 v[80:95], v[44:47], v[180:183], v[80:95]
    ds_read_b64_tr_b16 v[52:53], v17 offset:63488
    ds_read_b64_tr_b16 v[54:55], v17 offset:64000
    s_add_u32 m0, s67, 98304
    s_nop 0
    buffer_load_dwordx4 v10, s[8:11], s84 offen lds
    s_waitcnt lgkmcnt(5)
    v_mfma_f32_32x32x16_bf16 v[64:79], v[120:123], v[184:187], v[64:79]
    ds_read_b128 v[192:195], v12 offset:0
    ds_read_b64_tr_b16 v[112:113], v17 offset:0
    ds_read_b64_tr_b16 v[114:115], v17 offset:512
    v_mfma_f32_32x32x16_bf16 v[80:95], v[48:51], v[184:187], v[80:95]
    ds_read_b64_tr_b16 v[40:41], v17 offset:8192
    ds_read_b64_tr_b16 v[42:43], v17 offset:8704
    s_add_u32 m0, s64, 33792
    s_nop 0
    buffer_load_dwordx4 v9, s[4:7], s76 offen lds
    v_mfma_f32_32x32x16_bf16 v[96:111], v[60:63], v[36:39], v[96:111]
    s_waitcnt lgkmcnt(5)
    v_mfma_f32_32x32x16_bf16 v[64:79], v[124:127], v[188:191], v[64:79]
    ds_read_b128 v[196:199], v13 offset:0
    ds_read_b64_tr_b16 v[116:117], v17 offset:2048
    ds_read_b64_tr_b16 v[118:119], v17 offset:2560
    v_mfma_f32_32x32x16_bf16 v[80:95], v[52:55], v[188:191], v[80:95]
    ds_read_b64_tr_b16 v[44:45], v17 offset:10240
    ds_read_b64_tr_b16 v[46:47], v17 offset:10752
    s_add_u32 m0, s67, 106496
    s_nop 0
    buffer_load_dwordx4 v11, s[8:11], s84 offen lds
    s_waitcnt vmcnt(5)
    s_barrier
    ds_read_b64_tr_b16 v[32:33], v19 offset:0
    ds_read_b64_tr_b16 v[34:35], v19 offset:512
    ds_read_b64_tr_b16 v[36:37], v19 offset:8192
    ds_read_b64_tr_b16 v[38:39], v19 offset:8704
    s_waitcnt lgkmcnt(9)
    v_mfma_f32_32x32x16_bf16 v[64:79], v[112:115], v[192:195], v[64:79]
    ds_read_b128 v[200:203], v14 offset:0
    ds_read_b64_tr_b16 v[120:121], v17 offset:4096
    ds_read_b64_tr_b16 v[122:123], v17 offset:4608
    v_mfma_f32_32x32x16_bf16 v[80:95], v[40:43], v[192:195], v[80:95]
    ds_read_b64_tr_b16 v[48:49], v17 offset:12288
    ds_read_b64_tr_b16 v[50:51], v17 offset:12800
    s_add_u32 m0, s64, 49152
    s_nop 0
    buffer_load_dwordx4 v8, s[4:7], s77 offen lds
    s_waitcnt lgkmcnt(9)
    v_mfma_f32_32x32x16_bf16 v[64:79], v[116:119], v[196:199], v[64:79]
    ds_read_b128 v[204:207], v15 offset:0
    ds_read_b64_tr_b16 v[124:125], v17 offset:6144
    ds_read_b64_tr_b16 v[126:127], v17 offset:6656
    s_waitcnt lgkmcnt(8)
    v_mfma_f32_32x32x16_bf16 v[96:111], v[56:59], v[32:35], v[96:111]
    v_mfma_f32_32x32x16_bf16 v[80:95], v[44:47], v[196:199], v[80:95]
    ds_read_b64_tr_b16 v[52:53], v17 offset:14336
    ds_read_b64_tr_b16 v[54:55], v17 offset:14848
    s_add_u32 m0, s67, 114688
    s_nop 0
    buffer_load_dwordx4 v10, s[8:11], s85 offen lds
    s_waitcnt lgkmcnt(5)
    v_mfma_f32_32x32x16_bf16 v[64:79], v[120:123], v[200:203], v[64:79]
    ds_read_b128 v[208:211], v12 offset:16384
    ds_read_b64_tr_b16 v[112:113], v17 offset:16384
    ds_read_b64_tr_b16 v[114:115], v17 offset:16896
    v_mfma_f32_32x32x16_bf16 v[80:95], v[48:51], v[200:203], v[80:95]
    ds_read_b64_tr_b16 v[40:41], v17 offset:24576
    ds_read_b64_tr_b16 v[42:43], v17 offset:25088
    s_add_u32 m0, s64, 50176
    s_nop 0
    buffer_load_dwordx4 v9, s[4:7], s77 offen lds
    v_mfma_f32_32x32x16_bf16 v[96:111], v[60:63], v[36:39], v[96:111]
    s_waitcnt lgkmcnt(5)
    v_mfma_f32_32x32x16_bf16 v[64:79], v[124:127], v[204:207], v[64:79]
    ds_read_b128 v[212:215], v13 offset:16384
    ds_read_b64_tr_b16 v[116:117], v17 offset:18432
    ds_read_b64_tr_b16 v[118:119], v17 offset:18944
    v_mfma_f32_32x32x16_bf16 v[80:95], v[52:55], v[204:207], v[80:95]
    ds_read_b64_tr_b16 v[44:45], v17 offset:26624
    ds_read_b64_tr_b16 v[46:47], v17 offset:27136
    s_add_u32 m0, s67, 122880
    s_nop 0
    buffer_load_dwordx4 v11, s[8:11], s85 offen lds
    s_waitcnt vmcnt(4)
    s_barrier
    ds_read_b64_tr_b16 v[32:33], v19 offset:16384
    ds_read_b64_tr_b16 v[34:35], v19 offset:16896
    ds_read_b64_tr_b16 v[36:37], v19 offset:24576
    ds_read_b64_tr_b16 v[38:39], v19 offset:25088
    s_mov_b32 s96, 0
Lnp_35:
    v_readfirstlane_b32 s52, v22
    v_readfirstlane_b32 s53, v23
    s_nop 0
    s_xor_b32 s95, s52, s53
    s_cmp_eq_u32 s95, 0x5bd1e995
    s_cbranch_scc1 Lnd_36
    s_add_u32 s96, s96, 1
    s_cmp_gt_u32 s96, 20000
    s_cbranch_scc1 Lnd_36
    s_sleep 1
    buffer_load_dwordx2 v[22:23], v4, s[40:43], 0 offen sc1
    s_waitcnt vmcnt(0)
    s_branch Lnp_35
Lnd_36:
    s_waitcnt lgkmcnt(9)
    v_mfma_f32_32x32x16_bf16 v[64:79], v[112:115], v[208:211], v[64:79]
    ds_read_b128 v[216:219], v14 offset:16384
    ds_read_b64_tr_b16 v[120:121], v17 offset:20480
    ds_read_b64_tr_b16 v[122:123], v17 offset:20992
    v_mfma_f32_32x32x16_bf16 v[80:95], v[40:43], v[208:211], v[80:95]
    ds_read_b64_tr_b16 v[48:49], v17 offset:28672
    ds_read_b64_tr_b16 v[50:51], v17 offset:29184
    s_add_u32 m0, s67, 0
    s_nop 0
    buffer_load_dwordx4 v5, s[8:11], s78 offen lds
    s_waitcnt lgkmcnt(9)
    v_mfma_f32_32x32x16_bf16 v[64:79], v[116:119], v[212:215], v[64:79]
    ds_read_b128 v[220:223], v15 offset:16384
    ds_read_b64_tr_b16 v[124:125], v17 offset:22528
    ds_read_b64_tr_b16 v[126:127], v17 offset:23040
    s_waitcnt lgkmcnt(8)
    v_mfma_f32_32x32x16_bf16 v[96:111], v[56:59], v[32:35], v[96:111]
    v_mfma_f32_32x32x16_bf16 v[80:95], v[44:47], v[212:215], v[80:95]
    ds_read_b64_tr_b16 v[52:53], v17 offset:30720
    ds_read_b64_tr_b16 v[54:55], v17 offset:31232
    s_add_u32 m0, s67, 65536
    s_nop 0
    buffer_load_dwordx4 v5, s[8:11], s82 offen lds
    s_waitcnt lgkmcnt(5)
    v_mfma_f32_32x32x16_bf16 v[64:79], v[120:123], v[216:219], v[64:79]
    ds_read_b128 v[224:227], v12 offset:32768
    ds_read_b64_tr_b16 v[112:113], v17 offset:32768
    ds_read_b64_tr_b16 v[114:115], v17 offset:33280
    v_mfma_f32_32x32x16_bf16 v[80:95], v[48:51], v[216:219], v[80:95]
    ds_read_b64_tr_b16 v[40:41], v17 offset:40960
    ds_read_b64_tr_b16 v[42:43], v17 offset:41472
    s_add_u32 m0, s67, 8192
    s_nop 0
    buffer_load_dwordx4 v5, s[8:11], s79 offen lds
    v_mfma_f32_32x32x16_bf16 v[96:111], v[60:63], v[36:39], v[96:111]
    s_waitcnt lgkmcnt(5)
    v_mfma_f32_32x32x16_bf16 v[64:79], v[124:127], v[220:223], v[64:79]
    ds_read_b128 v[228:231], v13 offset:32768
    ds_read_b64_tr_b16 v[116:117], v17 offset:34816
    ds_read_b64_tr_b16 v[118:119], v17 offset:35328
    v_mfma_f32_32x32x16_bf16 v[80:95], v[52:55], v[220:223], v[80:95]
    ds_read_b64_tr_b16 v[44:45], v17 offset:43008
    ds_read_b64_tr_b16 v[46:47], v17 offset:43520
    s_add_u32 m0, s67, 73728
    s_nop 0
    buffer_load_dwordx4 v5, s[8:11], s83 offen lds
    s_waitcnt vmcnt(4)
    s_barrier
    ds_read_b64_tr_b16 v[32:33], v19 offset:32768
    ds_read_b64_tr_b16 v[34:35], v19 offset:33280
    ds_read_b64_tr_b16 v[36:37], v19 offset:40960
    ds_read_b64_tr_b16 v[38:39], v19 offset:41472
    buffer_load_dwordx2 v[22:23], v18, s[44:47], 0 offen sc1
    s_waitcnt lgkmcnt(9)
    v_mfma_f32_32x32x16_bf16 v[64:79], v[112:115], v[224:227], v[64:79]
    ds_read_b128 v[232:235], v14 offset:32768
    ds_read_b64_tr_b16 v[120:121], v17 offset:36864
    ds_read_b64_tr_b16 v[122:123], v17 offset:37376
    v_mfma_f32_32x32x16_bf16 v[80:95], v[40:43], v[224:227], v[80:95]
    ds_read_b64_tr_b16 v[48:49], v17 offset:45056
    ds_read_b64_tr_b16 v[50:51], v17 offset:45568
    s_add_u32 m0, s67, 16384
    s_nop 0
    buffer_load_dwordx4 v5, s[8:11], s80 offen lds
    s_waitcnt lgkmcnt(9)
    v_mfma_f32_32x32x16_bf16 v[64:79], v[116:119], v[228:231], v[64:79]
    ds_read_b128 v[236:239], v15 offset:32768
    ds_read_b64_tr_b16 v[124:125], v17 offset:38912
    ds_read_b64_tr_b16 v[126:127], v17 offset:39424
    s_waitcnt lgkmcnt(8)
    v_mfma_f32_32x32x16_bf16 v[96:111], v[56:59], v[32:35], v[96:111]
    v_mfma_f32_32x32x16_bf16 v[80:95], v[44:47], v[228:231], v[80:95]
    ds_read_b64_tr_b16 v[52:53], v17 offset:47104
    ds_read_b64_tr_b16 v[54:55], v17 offset:47616
    s_add_u32 m0, s67, 81920
    s_nop 0
    buffer_load_dwordx4 v5, s[8:11], s84 offen lds
    s_waitcnt lgkmcnt(5)
    v_mfma_f32_32x32x16_bf16 v[64:79], v[120:123], v[232:235], v[64:79]
    ds_read_b128 v[240:243], v12 offset:49152
    ds_read_b64_tr_b16 v[112:113], v17 offset:49152
    ds_read_b64_tr_b16 v[114:115], v17 offset:49664
    v_mfma_f32_32x32x16_bf16 v[80:95], v[48:51], v[232:235], v[80:95]
    ds_read_b64_tr_b16 v[40:41], v17 offset:57344
    ds_read_b64_tr_b16 v[42:43], v17 offset:57856
    s_add_u32 m0, s67, 24576
    s_nop 0
    buffer_load_dwordx4 v5, s[8:11], s81 offen lds
    v_mfma_f32_32x32x16_bf16 v[96:111], v[60:63], v[36:39], v[96:111]
    s_waitcnt lgkmcnt(5)
    v_mfma_f32_32x32x16_bf16 v[64:79], v[124:127], v[236:239], v[64:79]
    ds_read_b128 v[244:247], v13 offset:49152
    ds_read_b64_tr_b16 v[116:117], v17 offset:51200
    ds_read_b64_tr_b16 v[118:119], v17 offset:51712
    v_mfma_f32_32x32x16_bf16 v[80:95], v[52:55], v[236:239], v[80:95]
    ds_read_b64_tr_b16 v[44:45], v17 offset:59392
    ds_read_b64_tr_b16 v[46:47], v17 offset:59904
    s_add_u32 m0, s67, 90112
    s_nop 0
    buffer_load_dwordx4 v5, s[8:11], s85 offen lds
    s_barrier
    ds_read_b64_tr_b16 v[32:33], v19 offset:49152
    ds_read_b64_tr_b16 v[34:35], v19 offset:49664
    ds_read_b64_tr_b16 v[36:37], v19 offset:57344
    ds_read_b64_tr_b16 v[38:39], v19 offset:57856
    s_waitcnt vmcnt(4)
    v_cmp_ne_u64 vcc, s[52:53], v[22:23]
    s_nop 0
    s_cmp_eq_u64 vcc, 0
    s_cbranch_scc1 Lok_37
    s_mov_b32 s96, 0
    s_mov_b64 exec, -1
Lpoll_38:
    buffer_load_dwordx2 v[22:23], v18, s[44:47], 0 offen sc1
    s_waitcnt vmcnt(0)
    v_cmp_ne_u64 vcc, s[52:53], v[22:23]
    s_add_u32 s96, s96, 1
    s_cmp_eq_u64 vcc, 0
    s_cbranch_scc1 Lpd_39
    s_mov_b64 exec, vcc
    s_cmp_gt_u32 s96, 20000
    s_cbranch_scc1 Lpd_39
    s_sleep 1
    s_branch Lpoll_38
Lpd_39:
    s_mov_b64 exec, -1
Lok_37:
    v_and_b32 v2, 31, v1
    v_lshlrev_b32 v2, 3, v2
    buffer_load_dwordx2 v[22:23], v2, s[44:47], s60 offen sc1
    s_waitcnt lgkmcnt(9)
    v_mfma_f32_32x32x16_bf16 v[64:79], v[112:115], v[240:243], v[64:79]
    ds_read_b128 v[248:251], v14 offset:49152
    ds_read_b64_tr_b16 v[120:121], v17 offset:53248
    ds_read_b64_tr_b16 v[122:123], v17 offset:53760
    v_and_b32 v3, 31, v1
    v_lshlrev_b32 v3, 6, v3
    s_lshl_b32 s54, s58, 11
    v_mfma_f32_32x32x16_bf16 v[80:95], v[40:43], v[240:243], v[80:95]
    ds_read_b64_tr_b16 v[48:49], v17 offset:61440
    ds_read_b64_tr_b16 v[50:51], v17 offset:61952
    v_add_u32 v3, s54, v3
    v_bfe_u32 v4, v1, 1, 3
    v_lshrrev_b32 v2, 5, v1
    s_waitcnt lgkmcnt(9)
    v_mfma_f32_32x32x16_bf16 v[64:79], v[116:119], v[244:247], v[64:79]
    ds_read_b128 v[252:255], v15 offset:49152
    ds_read_b64_tr_b16 v[124:125], v17 offset:55296
    ds_read_b64_tr_b16 v[126:127], v17 offset:55808
    s_waitcnt lgkmcnt(8)
    v_mfma_f32_32x32x16_bf16 v[96:111], v[56:59], v[32:35], v[96:111]
    v_xor_b32 v4, v4, v2
    s_lshl_b32 s55, s59, 13
    s_sub_u32 s66, 65536, s55
    v_mfma_f32_32x32x16_bf16 v[80:95], v[44:47], v[244:247], v[80:95]
    ds_read_b64_tr_b16 v[52:53], v17 offset:63488
    ds_read_b64_tr_b16 v[54:55], v17 offset:64000
    s_add_u32 s55, s55, 98304
    v_add_u32 v3, s55, v3
    v_xor_b32 v8, 0, v4
    s_waitcnt lgkmcnt(5)
    v_mfma_f32_32x32x16_bf16 v[64:79], v[120:123], v[248:251], v[64:79]
    v_lshl_add_u32 v8, v8, 3, v3
    v_xor_b32 v9, 2, v4
    v_lshl_add_u32 v9, v9, 3, v3
    v_mfma_f32_32x32x16_bf16 v[80:95], v[48:51], v[248:251], v[80:95]
    v_mfma_f32_32x32x16_bf16 v[96:111], v[60:63], v[36:39], v[96:111]
    v_xor_b32 v10, 4, v4
    v_lshl_add_u32 v10, v10, 3, v3
    v_xor_b32 v11, 6, v4
    s_waitcnt lgkmcnt(0)
    v_mfma_f32_32x32x16_bf16 v[64:79], v[124:127], v[252:255], v[64:79]
    v_lshl_add_u32 v11, v11, 3, v3
    v_cmp_gt_u32 vcc, 32, v1
    v_mfma_f32_32x32x16_bf16 v[80:95], v[52:55], v[252:255], v[80:95]
    s_nop 3
    v_cndmask_b32 v96, v104, v96, vcc
    ds_write_b32 v20, v96
    s_add_u32 s54, s57, 128
    s_lshl_b32 s54, s54, 7
    s_add_u32 s54, s54, 8519680
    v_mov_b32 v5, s54
    s_waitcnt vmcnt(0)
    buffer_load_dwordx2 v[28:29], v5, s[44:47], 0 offen sc1
    v_sub_f32 v2, 0, v22
    v_cvt_pk_bf16_f32 v2, v2, v2
    v_and_b32 v3, 0xffff0000, v2
    v_add_f32 v4, v22, v3
    v_sub_f32 v4, 0, v4
    v_cvt_pk_bf16_f32 v3, v4, v3
    v_cmp_gt_u32 vcc, 32, v1
    s_nop 1
    v_cndmask_b32 v2, v30, v2, vcc
    v_cndmask_b32 v3, v30, v3, vcc
    v_mul_f32 v22, 0x3fb8aa3b, v23
    v_mov_b32 v56, v2
    v_mov_b32 v57, v3
    v_mov_b32 v58, 0
    v_mov_b32 v59, 0
    v_subrev_u32 v12, s66, v8
    v_subrev_u32 v13, s66, v9
    v_subrev_u32 v14, s66, v10
    v_subrev_u32 v15, s66, v11
    s_waitcnt lgkmcnt(0)
    s_barrier
    ds_read_b128 v[100:103], v21 offset:0
    ds_read_b128 v[108:111], v21 offset:512
    s_waitcnt lgkmcnt(1)
    v_add_f32 v100, v100, v101
    v_add_f32 v102, v102, v103
    v_add_f32 v100, v100, v102
    v_cvt_pk_bf16_f32 v98, v100, v100
    v_and_b32 v98, 0xffff0000, v98
    v_sub_f32 v100, v100, v98
    v_cvt_pk_bf16_f32 v96, v98, v100
    v_and_b32 v99, 0xffff0000, v96
    v_sub_f32 v100, v100, v99
    v_cvt_pk_bf16_f32 v97, v98, v100
    s_nop 1
    v_mfma_f32_32x32x16_bf16 v[64:79], v[96:99], v[56:59], v[64:79]
    s_waitcnt lgkmcnt(0)
    v_add_f32 v108, v108, v109
    v_add_f32 v110, v110, v111
    v_add_f32 v108, v108, v110
    v_cvt_pk_bf16_f32 v106, v108, v108
    v_and_b32 v106, 0xffff0000, v106
    v_sub_f32 v108, v108, v106
    v_cvt_pk_bf16_f32 v104, v106, v108
    v_and_b32 v107, 0xffff0000, v104
    v_sub_f32 v108, v108, v107
    v_cvt_pk_bf16_f32 v105, v106, v108
    s_nop 1
    v_mfma_f32_32x32x16_bf16 v[80:95], v[104:107], v[56:59], v[80:95]
    v_cvt_pk_bf16_f32 v64, v64, v65
    v_cvt_pk_bf16_f32 v65, v66, v67
    v_cvt_pk_bf16_f32 v66, v68, v69
    v_cvt_pk_bf16_f32 v67, v70, v71
    v_cvt_pk_bf16_f32 v68, v72, v73
    v_cvt_pk_bf16_f32 v69, v74, v75
    v_cvt_pk_bf16_f32 v70, v76, v77
    v_cvt_pk_bf16_f32 v71, v78, v79
    s_nop 3
    v_mul_f32 v80, v80, v23
    v_mul_f32 v81, v81, v23
    v_mul_f32 v82, v82, v23
    v_mul_f32 v83, v83, v23
    v_mul_f32 v84, v84, v23
    v_mul_f32 v85, v85, v23
    v_mul_f32 v86, v86, v23
    v_mul_f32 v87, v87, v23
    v_mul_f32 v88, v88, v23
    v_mul_f32 v89, v89, v23
    v_mul_f32 v90, v90, v23
    v_mul_f32 v91, v91, v23
    v_mul_f32 v92, v92, v23
    v_mul_f32 v93, v93, v23
    v_mul_f32 v94, v94, v23
    v_mul_f32 v95, v95, v23
    v_cvt_pk_bf16_f32 v72, v80, v81
    v_cvt_pk_bf16_f32 v73, v82, v83
    v_cvt_pk_bf16_f32 v74, v84, v85
    v_cvt_pk_bf16_f32 v75, v86, v87
    v_cvt_pk_bf16_f32 v76, v88, v89
    v_cvt_pk_bf16_f32 v77, v90, v91
    v_cvt_pk_bf16_f32 v78, v92, v93
    v_cvt_pk_bf16_f32 v79, v94, v95
    ds_write_b64 v8, v[72:73]
    ds_write_b64 v9, v[74:75]
    ds_write_b64 v10, v[76:77]
    ds_write_b64 v11, v[78:79]
    v_lshrrev_b32 v2, 3, v1
    v_lshlrev_b32 v2, 12, v2
    v_and_b32 v3, 7, v1
    v_lshl_add_u32 v2, v3, 7, v2
    s_and_b32 s66, s49, 1
    s_lshl_b32 s66, s66, 4
    s_add_u32 s66, s66, s50
    s_mul_i32 s66, s66, 176128
    s_lshr_b32 s54, s49, 1
    s_lshl_b32 s54, s54, 10
    s_add_u32 s66, s66, s54
    s_mul_i32 s54, s48, 20480
    s_add_u32 s54, s54, s66
    s_mov_b32 exec_hi, 0xff
    buffer_load_dword v20, v2, s[28:31], s54 offen
    s_mov_b64 exec, -1
    v_mfma_f32_32x32x16_bf16 v[96:111], v[24:27], v[64:67], 0
    v_mfma_f32_32x32x16_bf16 v[112:127], v[24:27], v[68:71], 0
    s_nop 10
    v_max3_f32 v32, v96, v97, v98
    v_max3_f32 v36, v120, v121, v122
    v_min3_f32 v33, v96, v97, v98
    v_min3_f32 v37, v120, v121, v122
    v_max3_f32 v32, v32, v99, v100
    v_max3_f32 v36, v36, v123, v124
    v_min3_f32 v33, v33, v99, v100
    v_min3_f32 v37, v37, v123, v124
    v_max3_f32 v32, v32, v101, v102
    v_max3_f32 v36, v36, v125, v126
    v_min3_f32 v33, v33, v101, v102
    v_min3_f32 v37, v37, v125, v126
    v_max_f32 v32, v32, v103
    v_max_f32 v36, v36, v127
    v_max_f32 v33, -v33, -v103
    v_max_f32 v37, -v37, -v127
    s_nop 0
    v_permlane32_swap_b32 v32, v33
    v_permlane32_swap_b32 v36, v37
    v_max_f32 v32, v32, v33
    v_max_f32 v36, v36, v37
    v_mul_f32 v32, v22, v32
    v_mul_f32 v36, v22, v36
    v_mov_b32 v33, v32
    v_mov_b32 v37, v36
    s_nop 0
    v_permlane32_swap_b32 v32, v33
    v_permlane32_swap_b32 v36, v37
    v_fma_f32 v104, v96, v22, -v32
    v_fma_f32 v112, v120, v22, -v36
    v_fma_f32 v96, -v96, v22, -v33
    v_fma_f32 v120, -v120, v22, -v37
    v_fma_f32 v105, v97, v22, -v32
    v_fma_f32 v113, v121, v22, -v36
    v_fma_f32 v97, -v97, v22, -v33
    v_fma_f32 v121, -v121, v22, -v37
    v_fma_f32 v106, v98, v22, -v32
    v_fma_f32 v114, v122, v22, -v36
    v_fma_f32 v98, -v98, v22, -v33
    v_fma_f32 v122, -v122, v22, -v37
    v_fma_f32 v107, v99, v22, -v32
    v_fma_f32 v115, v123, v22, -v36
    v_fma_f32 v99, -v99, v22, -v33
    v_fma_f32 v123, -v123, v22, -v37
    v_fma_f32 v108, v100, v22, -v32
    v_fma_f32 v116, v124, v22, -v36
    v_fma_f32 v100, -v100, v22, -v33
    v_fma_f32 v124, -v124, v22, -v37
    v_fma_f32 v109, v101, v22, -v32
    v_fma_f32 v117, v125, v22, -v36
    v_fma_f32 v101, -v101, v22, -v33
    v_fma_f32 v125, -v125, v22, -v37
    v_fma_f32 v110, v102, v22, -v32
    v_fma_f32 v118, v126, v22, -v36
    v_fma_f32 v102, -v102, v22, -v33
    v_fma_f32 v126, -v126, v22, -v37
    v_fma_f32 v111, v103, v22, -v32
    v_fma_f32 v119, v127, v22, -v36
    v_fma_f32 v103, -v103, v22, -v33
    v_fma_f32 v127, -v127, v22, -v37
    v_exp_f32 v104, v104
    v_exp_f32 v112, v112
    v_exp_f32 v96, v96
    v_exp_f32 v120, v120
    v_exp_f32 v105, v105
    v_exp_f32 v113, v113
    v_exp_f32 v97, v97
    v_exp_f32 v121, v121
    v_exp_f32 v106, v106
    v_exp_f32 v114, v114
    v_exp_f32 v98, v98
    v_exp_f32 v122, v122
    v_exp_f32 v107, v107
    v_exp_f32 v115, v115
    v_exp_f32 v99, v99
    v_exp_f32 v123, v123
    v_exp_f32 v108, v108
    v_exp_f32 v116, v116
    v_exp_f32 v100, v100
    v_exp_f32 v124, v124
    v_exp_f32 v109, v109
    v_exp_f32 v117, v117
    v_exp_f32 v101, v101
    v_exp_f32 v125, v125
    v_exp_f32 v110, v110
    v_exp_f32 v118, v118
    v_exp_f32 v102, v102
    v_exp_f32 v126, v126
    v_exp_f32 v111, v111
    v_exp_f32 v119, v119
    v_exp_f32 v103, v103
    v_exp_f32 v127, v127
    v_add_f32 v34, v104, v105
    v_add_f32 v38, v112, v113
    v_add_f32 v35, v96, v97
    v_add_f32 v39, v120, v121
    v_add_f32 v34, v34, v106
    v_add_f32 v38, v38, v114
    v_add_f32 v35, v35, v98
    v_add_f32 v39, v39, v122
    v_add_f32 v34, v34, v107
    v_add_f32 v38, v38, v115
    v_add_f32 v35, v35, v99
    v_add_f32 v39, v39, v123
    v_add_f32 v34, v34, v108
    v_add_f32 v38, v38, v116
    v_add_f32 v35, v35, v100
    v_add_f32 v39, v39, v124
    v_add_f32 v34, v34, v109
    v_add_f32 v38, v38, v117
    v_add_f32 v35, v35, v101
    v_add_f32 v39, v39, v125
    v_add_f32 v34, v34, v110
    v_add_f32 v38, v38, v118
    v_add_f32 v35, v35, v102
    v_add_f32 v39, v39, v126
    v_add_f32 v34, v34, v111
    v_add_f32 v38, v38, v119
    v_add_f32 v35, v35, v103
    v_add_f32 v39, v39, v127
    s_nop 0
    v_permlane32_swap_b32 v34, v35
    v_permlane32_swap_b32 v38, v39
    v_add_f32 v34, v34, v35
    v_add_f32 v38, v38, v39
    v_rcp_f32 v34, v34
    v_rcp_f32 v38, v38
    v_mov_b32 v35, v34
    v_mov_b32 v39, v38
    s_nop 0
    v_permlane32_swap_b32 v34, v35
    v_permlane32_swap_b32 v38, v39
    v_mul_f32 v104, v104, v34
    v_mul_f32 v112, v112, v38
    v_mul_f32 v96, v96, v35
    v_mul_f32 v120, v120, v39
    v_mul_f32 v105, v105, v34
    v_mul_f32 v113, v113, v38
    v_mul_f32 v97, v97, v35
    v_mul_f32 v121, v121, v39
    v_mul_f32 v106, v106, v34
    v_mul_f32 v114, v114, v38
    v_mul_f32 v98, v98, v35
    v_mul_f32 v122, v122, v39
    v_mul_f32 v107, v107, v34
    v_mul_f32 v115, v115, v38
    v_mul_f32 v99, v99, v35
    v_mul_f32 v123, v123, v39
    v_mul_f32 v108, v108, v34
    v_mul_f32 v116, v116, v38
    v_mul_f32 v100, v100, v35
    v_mul_f32 v124, v124, v39
    v_mul_f32 v109, v109, v34
    v_mul_f32 v117, v117, v38
    v_mul_f32 v101, v101, v35
    v_mul_f32 v125, v125, v39
    v_mul_f32 v110, v110, v34
    v_mul_f32 v118, v118, v38
    v_mul_f32 v102, v102, v35
    v_mul_f32 v126, v126, v39
    v_mul_f32 v111, v111, v34
    v_mul_f32 v119, v119, v38
    v_mul_f32 v103, v103, v35
    v_mul_f32 v127, v127, v39
    v_cvt_pk_bf16_f32 v104, v104, v105
    v_cvt_pk_bf16_f32 v112, v112, v113
    v_cvt_pk_bf16_f32 v105, v106, v107
    v_cvt_pk_bf16_f32 v113, v114, v115
    v_cvt_pk_bf16_f32 v106, v108, v109
    v_cvt_pk_bf16_f32 v114, v116, v117
    v_cvt_pk_bf16_f32 v107, v110, v111
    v_cvt_pk_bf16_f32 v115, v118, v119
    v_cvt_pk_bf16_f32 v108, v96, v97
    v_cvt_pk_bf16_f32 v116, v120, v121
    v_cvt_pk_bf16_f32 v109, v98, v99
    v_cvt_pk_bf16_f32 v117, v122, v123
    v_cvt_pk_bf16_f32 v110, v100, v101
    v_cvt_pk_bf16_f32 v118, v124, v125
    v_cvt_pk_bf16_f32 v111, v102, v103
    v_cvt_pk_bf16_f32 v119, v126, v127
    ds_write_b64 v12, v[104:105] offset:0
    ds_write_b64 v12, v[112:113] offset:8192
    ds_write_b64 v13, v[106:107] offset:0
    ds_write_b64 v13, v[114:115] offset:8192
    ds_write_b64 v14, v[108:109] offset:0
    ds_write_b64 v14, v[116:117] offset:8192
    ds_write_b64 v15, v[110:111] offset:0
    ds_write_b64 v15, v[118:119] offset:8192
    s_waitcnt vmcnt(1)
    v_cmp_ne_u64 vcc, s[52:53], v[28:29]
    s_nop 0
    s_cmp_eq_u64 vcc, 0
    s_cbranch_scc1 Lok_40
    s_mov_b32 s96, 0
    s_mov_b64 exec, -1
Lpoll_41:
    buffer_load_dwordx2 v[28:29], v5, s[44:47], 0 offen sc1
    s_waitcnt vmcnt(0)
    v_cmp_ne_u64 vcc, s[52:53], v[28:29]
    s_add_u32 s96, s96, 1
    s_cmp_eq_u64 vcc, 0
    s_cbranch_scc1 Lpd_42
    s_mov_b64 exec, vcc
    s_cmp_gt_u32 s96, 20000
    s_cbranch_scc1 Lpd_42
    s_sleep 1
    s_branch Lpoll_41
Lpd_42:
    s_mov_b64 exec, -1
Lok_40:
    v_and_b32 v2, 31, v1
    v_lshlrev_b32 v2, 3, v2
    buffer_load_dwordx2 v[28:29], v2, s[44:47], s87 offen sc1
    v_bfe_u32 v2, v1, 2, 2
    v_lshrrev_b32 v3, 5, v1
    v_lshl_add_u32 v4, v3, 3, v2
    v_lshrrev_b32 v21, 1, v4
    v_lshlrev_b32 v4, 6, v4
    v_and_b32 v18, 3, v1
    v_bfe_u32 v19, v1, 4, 1
    v_lshl_add_u32 v19, v19, 2, v18
    s_and_b32 s54, s48, 1
    s_lshl_b32 s54, s54, 2
    v_add_u32 v18, s54, v18
    s_lshl_b32 s54, s58, 13
    s_add_u32 s54, s54, 32768
    s_lshr_b32 s55, s58, 1
    s_lshl_b32 s55, s55, 13
    s_add_u32 s55, s55, 98304
    v_xor_b32 v19, v19, v21
    v_xor_b32 v18, v18, v21
    v_lshl_add_u32 v60, v19, 3, v4
    v_add_u32 v60, s54, v60
    v_xor_b32 v61, 16, v60
    v_lshl_add_u32 v62, v18, 3, v4
    v_add_u32 v62, s55, v62
    v_xor_b32 v63, 16, v62
    v_and_b32 v18, 31, v1
    v_lshlrev_b32 v18, 2, v18
    v_lshl_add_u32 v18, v3, 9, v18
    s_lshl_b32 s60, s57, 14
    s_mul_i32 s55, s58, 2176
    s_add_u32 s60, s60, s55
    s_add_u32 s60, s60, 8912896
    v_and_b32 v2, 16, v1
    v_cmp_eq_u32 vcc, 0, v2
    v_mov_b32 v19, s89
    v_and_b32 v2, 15, v1
    v_lshlrev_b32 v2, 3, v2
    v_add_u32 v2, s57, v2
    v_lshlrev_b32 v21, 7, v2
    v_add_u32 v21, 8552448, v21
    s_waitcnt lgkmcnt(0)
    s_barrier
    s_cmp_gt_u32 s48, 3
    s_cbranch_scc1 Lkv_43
    ds_read_b64_tr_b16 v[64:65], v62 offset:0
    ds_read_b64_tr_b16 v[66:67], v63 offset:256
    ds_read_b64_tr_b16 v[68:69], v60 offset:0
    ds_read_b64_tr_b16 v[70:71], v61 offset:256
    ds_read_b64_tr_b16 v[72:73], v62 offset:1024
    ds_read_b64_tr_b16 v[74:75], v63 offset:1280
    ds_read_b64_tr_b16 v[76:77], v60 offset:1024
    ds_read_b64_tr_b16 v[78:79], v61 offset:1280
    ds_read_b64_tr_b16 v[80:81], v62 offset:2048
    ds_read_b64_tr_b16 v[82:83], v63 offset:2304
    ds_read_b64_tr_b16 v[84:85], v60 offset:2048
    ds_read_b64_tr_b16 v[86:87], v61 offset:2304
    s_waitcnt lgkmcnt(8)
    v_cndmask_b32 v64, v19, v64, vcc
    v_cndmask_b32 v65, v19, v65, vcc
    v_cndmask_b32 v66, v19, v66, vcc
    v_cndmask_b32 v67, v19, v67, vcc
    s_nop 1
    v_mfma_f32_32x32x16_bf16 v[40:55], v[64:67], v[68:71], 0
    ds_read_b64_tr_b16 v[88:89], v62 offset:3072
    ds_read_b64_tr_b16 v[90:91], v63 offset:3328
    ds_read_b64_tr_b16 v[92:93], v60 offset:3072
    ds_read_b64_tr_b16 v[94:95], v61 offset:3328
    s_waitcnt lgkmcnt(8)
    v_cndmask_b32 v72, v19, v72, vcc
    v_cndmask_b32 v73, v19, v73, vcc
    v_cndmask_b32 v74, v19, v74, vcc
    v_cndmask_b32 v75, v19, v75, vcc
    s_nop 1
    v_mfma_f32_32x32x16_bf16 v[40:55], v[72:75], v[76:79], v[40:55]
    ds_read_b64_tr_b16 v[96:97], v62 offset:4096
    ds_read_b64_tr_b16 v[98:99], v63 offset:4352
    ds_read_b64_tr_b16 v[100:101], v60 offset:4096
    ds_read_b64_tr_b16 v[102:103], v61 offset:4352
    s_waitcnt lgkmcnt(8)
    v_cndmask_b32 v80, v19, v80, vcc
    v_cndmask_b32 v81, v19, v81, vcc
    v_cndmask_b32 v82, v19, v82, vcc
    v_cndmask_b32 v83, v19, v83, vcc
    s_nop 1
    v_mfma_f32_32x32x16_bf16 v[40:55], v[80:83], v[84:87], v[40:55]
    ds_read_b64_tr_b16 v[104:105], v62 offset:5120
    ds_read_b64_tr_b16 v[106:107], v63 offset:5376
    ds_read_b64_tr_b16 v[108:109], v60 offset:5120
    ds_read_b64_tr_b16 v[110:111], v61 offset:5376
    s_waitcnt lgkmcnt(8)
    v_cndmask_b32 v88, v19, v88, vcc
    v_cndmask_b32 v89, v19, v89, vcc
    v_cndmask_b32 v90, v19, v90, vcc
    v_cndmask_b32 v91, v19, v91, vcc
    s_nop 1
    v_mfma_f32_32x32x16_bf16 v[40:55], v[88:91], v[92:95], v[40:55]
    ds_read_b64_tr_b16 v[112:113], v62 offset:6144
    ds_read_b64_tr_b16 v[114:115], v63 offset:6400
    ds_read_b64_tr_b16 v[116:117], v60 offset:6144
    ds_read_b64_tr_b16 v[118:119], v61 offset:6400
    s_waitcnt lgkmcnt(8)
    v_cndmask_b32 v96, v19, v96, vcc
    v_cndmask_b32 v97, v19, v97, vcc
    v_cndmask_b32 v98, v19, v98, vcc
    v_cndmask_b32 v99, v19, v99, vcc
    s_nop 1
    v_mfma_f32_32x32x16_bf16 v[40:55], v[96:99], v[100:103], v[40:55]
    ds_read_b64_tr_b16 v[120:121], v62 offset:7168
    ds_read_b64_tr_b16 v[122:123], v63 offset:7424
    ds_read_b64_tr_b16 v[124:125], v60 offset:7168
    ds_read_b64_tr_b16 v[126:127], v61 offset:7424
    s_waitcnt lgkmcnt(8)
    v_cndmask_b32 v104, v19, v104, vcc
    v_cndmask_b32 v105, v19, v105, vcc
    v_cndmask_b32 v106, v19, v106, vcc
    v_cndmask_b32 v107, v19, v107, vcc
    s_nop 1
    v_mfma_f32_32x32x16_bf16 v[40:55], v[104:107], v[108:111], v[40:55]
    s_waitcnt lgkmcnt(4)
    v_cndmask_b32 v112, v19, v112, vcc
    v_cndmask_b32 v113, v19, v113, vcc
    v_cndmask_b32 v114, v19, v114, vcc
    v_cndmask_b32 v115, v19, v115, vcc
    s_nop 1
    v_mfma_f32_32x32x16_bf16 v[40:55], v[112:115], v[116:119], v[40:55]
    s_waitcnt lgkmcnt(0)
    v_cndmask_b32 v120, v19, v120, vcc
    v_cndmask_b32 v121, v19, v121, vcc
    v_cndmask_b32 v122, v19, v122, vcc
    v_cndmask_b32 v123, v19, v123, vcc
    s_nop 1
    v_mfma_f32_32x32x16_bf16 v[40:55], v[120:123], v[124:127], v[40:55]
    s_nop 11
    v_mov_b32 v96, v40
    v_mov_b32 v97, v41
    v_mov_b32 v98, v42
    v_mov_b32 v99, v43
    v_mov_b32 v100, v44
    v_mov_b32 v101, v45
    v_mov_b32 v102, v46
    v_mov_b32 v103, v47
    v_mov_b32 v104, v48
    buffer_atomic_add_f32 v96, v18, s[44:47], s60 offen offset:0 sc1
    buffer_atomic_add_f32 v97, v18, s[44:47], s60 offen offset:128 sc1
    buffer_atomic_add_f32 v98, v18, s[44:47], s60 offen offset:256 sc1
    buffer_atomic_add_f32 v99, v18, s[44:47], s60 offen offset:384 sc1
    buffer_atomic_add_f32 v100, v18, s[44:47], s60 offen offset:1024 sc1
    buffer_atomic_add_f32 v101, v18, s[44:47], s60 offen offset:1152 sc1
    buffer_atomic_add_f32 v102, v18, s[44:47], s60 offen offset:1280 sc1
    buffer_atomic_add_f32 v103, v18, s[44:47], s60 offen offset:1408 sc1
    s_mov_b64 exec, 0xffffffff
    buffer_atomic_add_f32 v104, v18, s[44:47], s60 offen offset:2048 sc1
    s_mov_b64 exec, -1
Lkv_43:
    ds_read_b64_tr_b16 v[40:41], v16 offset:0
    ds_read_b64_tr_b16 v[42:43], v16 offset:512
    ds_read_b64_tr_b16 v[44:45], v16 offset:2048
    ds_read_b64_tr_b16 v[46:47], v16 offset:2560
    ds_read_b64_tr_b16 v[48:49], v16 offset:4096
    ds_read_b64_tr_b16 v[50:51], v16 offset:4608
    s_waitcnt lgkmcnt(4)
    v_mfma_f32_32x32x16_bf16 v[80:95], v[40:43], v[128:131], 0
    ds_read_b64_tr_b16 v[52:53], v16 offset:6144
    ds_read_b64_tr_b16 v[54:55], v16 offset:6656
    s_waitcnt lgkmcnt(4)
    v_mfma_f32_32x32x16_bf16 v[80:95], v[44:47], v[132:135], v[80:95]
    ds_read_b64_tr_b16 v[40:41], v16 offset:8192
    ds_read_b64_tr_b16 v[42:43], v16 offset:8704
    s_waitcnt lgkmcnt(4)
    v_mfma_f32_32x32x16_bf16 v[80:95], v[48:51], v[136:139], v[80:95]
    ds_read_b64_tr_b16 v[44:45], v16 offset:10240
    ds_read_b64_tr_b16 v[46:47], v16 offset:10752
    s_waitcnt lgkmcnt(4)
    v_mfma_f32_32x32x16_bf16 v[80:95], v[52:55], v[140:143], v[80:95]
    ds_read_b64_tr_b16 v[48:49], v16 offset:12288
    ds_read_b64_tr_b16 v[50:51], v16 offset:12800
    s_waitcnt lgkmcnt(4)
    v_mfma_f32_32x32x16_bf16 v[80:95], v[40:43], v[144:147], v[80:95]
    ds_read_b64_tr_b16 v[52:53], v16 offset:14336
    ds_read_b64_tr_b16 v[54:55], v16 offset:14848
    s_waitcnt lgkmcnt(4)
    v_mfma_f32_32x32x16_bf16 v[80:95], v[44:47], v[148:151], v[80:95]
    ds_read_b64_tr_b16 v[40:41], v16 offset:16384
    ds_read_b64_tr_b16 v[42:43], v16 offset:16896
    s_waitcnt lgkmcnt(4)
    v_mfma_f32_32x32x16_bf16 v[80:95], v[48:51], v[152:155], v[80:95]
    ds_read_b64_tr_b16 v[44:45], v16 offset:18432
    ds_read_b64_tr_b16 v[46:47], v16 offset:18944
    s_waitcnt lgkmcnt(4)
    v_mfma_f32_32x32x16_bf16 v[80:95], v[52:55], v[156:159], v[80:95]
    ds_read_b64_tr_b16 v[48:49], v16 offset:20480
    ds_read_b64_tr_b16 v[50:51], v16 offset:20992
    s_waitcnt lgkmcnt(4)
    v_mfma_f32_32x32x16_bf16 v[80:95], v[40:43], v[160:163], v[80:95]
    ds_read_b64_tr_b16 v[52:53], v16 offset:22528
    ds_read_b64_tr_b16 v[54:55], v16 offset:23040
    s_waitcnt lgkmcnt(4)
    v_mfma_f32_32x32x16_bf16 v[80:95], v[44:47], v[164:167], v[80:95]
    ds_read_b64_tr_b16 v[40:41], v16 offset:24576
    ds_read_b64_tr_b16 v[42:43], v16 offset:25088
    s_waitcnt lgkmcnt(4)
    v_mfma_f32_32x32x16_bf16 v[80:95], v[48:51], v[168:171], v[80:95]
    ds_read_b64_tr_b16 v[44:45], v16 offset:26624
    ds_read_b64_tr_b16 v[46:47], v16 offset:27136
    s_waitcnt lgkmcnt(4)
    v_mfma_f32_32x32x16_bf16 v[80:95], v[52:55], v[172:175], v[80:95]
    ds_read_b64_tr_b16 v[48:49], v16 offset:28672
    ds_read_b64_tr_b16 v[50:51], v16 offset:29184
    s_waitcnt lgkmcnt(4)
    v_mfma_f32_32x32x16_bf16 v[80:95], v[40:43], v[176:179], v[80:95]
    ds_read_b64_tr_b16 v[52:53], v16 offset:30720
    ds_read_b64_tr_b16 v[54:55], v16 offset:31232
    s_waitcnt lgkmcnt(4)
    v_mfma_f32_32x32x16_bf16 v[80:95], v[44:47], v[180:183], v[80:95]
    ds_read_b64_tr_b16 v[40:41], v17 offset:0
    ds_read_b64_tr_b16 v[42:43], v17 offset:512
    s_waitcnt lgkmcnt(4)
    v_mfma_f32_32x32x16_bf16 v[80:95], v[48:51], v[184:187], v[80:95]
    ds_read_b64_tr_b16 v[44:45], v17 offset:2048
    ds_read_b64_tr_b16 v[46:47], v17 offset:2560
    s_cmp_gt_u32 s48, 3
    s_cbranch_scc1 Lkf_44
    v_mov_b32 v106, s52
    v_mov_b32 v107, s53
    v_mov_b32 v108, 0
    v_mov_b32 v109, 1
    v_mov_b32 v110, 163836
    s_waitcnt vmcnt(0)
    s_mov_b64 exec, 1
    ds_add_rtn_u32 v109, v110, v109
    s_waitcnt lgkmcnt(0)
    v_readfirstlane_b32 s95, v109
    s_nop 0
    s_cmp_lg_u32 s95, 3
    s_cbranch_scc1 Llf_45
    buffer_store_dwordx2 v[106:107], v108, s[44:47], s63 offen sc1
Llf_45:
    s_mov_b64 exec, -1
Lkf_44:
    s_waitcnt lgkmcnt(4)
    v_mfma_f32_32x32x16_bf16 v[80:95], v[52:55], v[188:191], v[80:95]
    ds_read_b64_tr_b16 v[48:49], v17 offset:4096
    ds_read_b64_tr_b16 v[50:51], v17 offset:4608
    s_waitcnt lgkmcnt(4)
    v_mfma_f32_32x32x16_bf16 v[80:95], v[40:43], v[192:195], v[80:95]
    ds_read_b64_tr_b16 v[52:53], v17 offset:6144
    ds_read_b64_tr_b16 v[54:55], v17 offset:6656
    s_waitcnt lgkmcnt(4)
    v_mfma_f32_32x32x16_bf16 v[80:95], v[44:47], v[196:199], v[80:95]
    ds_read_b64_tr_b16 v[40:41], v17 offset:8192
    ds_read_b64_tr_b16 v[42:43], v17 offset:8704
    s_waitcnt lgkmcnt(4)
    v_mfma_f32_32x32x16_bf16 v[80:95], v[48:51], v[200:203], v[80:95]
    ds_read_b64_tr_b16 v[44:45], v17 offset:10240
    ds_read_b64_tr_b16 v[46:47], v17 offset:10752
    s_waitcnt lgkmcnt(4)
    v_mfma_f32_32x32x16_bf16 v[80:95], v[52:55], v[204:207], v[80:95]
    ds_read_b64_tr_b16 v[48:49], v17 offset:12288
    ds_read_b64_tr_b16 v[50:51], v17 offset:12800
    s_waitcnt lgkmcnt(4)
    v_mfma_f32_32x32x16_bf16 v[80:95], v[40:43], v[208:211], v[80:95]
    ds_read_b64_tr_b16 v[52:53], v17 offset:14336
    ds_read_b64_tr_b16 v[54:55], v17 offset:14848
    s_waitcnt lgkmcnt(4)
    v_mfma_f32_32x32x16_bf16 v[80:95], v[44:47], v[212:215], v[80:95]
    ds_read_b64_tr_b16 v[40:41], v17 offset:16384
    ds_read_b64_tr_b16 v[42:43], v17 offset:16896
    s_waitcnt lgkmcnt(4)
    v_mfma_f32_32x32x16_bf16 v[80:95], v[48:51], v[216:219], v[80:95]
    ds_read_b64_tr_b16 v[44:45], v17 offset:18432
    ds_read_b64_tr_b16 v[46:47], v17 offset:18944
    s_waitcnt lgkmcnt(4)
    v_mfma_f32_32x32x16_bf16 v[80:95], v[52:55], v[220:223], v[80:95]
    ds_read_b64_tr_b16 v[48:49], v17 offset:20480
    ds_read_b64_tr_b16 v[50:51], v17 offset:20992
    s_waitcnt lgkmcnt(4)
    v_mfma_f32_32x32x16_bf16 v[80:95], v[40:43], v[224:227], v[80:95]
    ds_read_b64_tr_b16 v[52:53], v17 offset:22528
    ds_read_b64_tr_b16 v[54:55], v17 offset:23040
    s_waitcnt lgkmcnt(4)
    v_mfma_f32_32x32x16_bf16 v[80:95], v[44:47], v[228:231], v[80:95]
    ds_read_b64_tr_b16 v[40:41], v17 offset:24576
    ds_read_b64_tr_b16 v[42:43], v17 offset:25088
    s_waitcnt lgkmcnt(4)
    v_mfma_f32_32x32x16_bf16 v[80:95], v[48:51], v[232:235], v[80:95]
    ds_read_b64_tr_b16 v[44:45], v17 offset:26624
    ds_read_b64_tr_b16 v[46:47], v17 offset:27136
    s_waitcnt lgkmcnt(4)
    v_mfma_f32_32x32x16_bf16 v[80:95], v[52:55], v[236:239], v[80:95]
    ds_read_b64_tr_b16 v[48:49], v17 offset:28672
    ds_read_b64_tr_b16 v[50:51], v17 offset:29184
    s_waitcnt lgkmcnt(4)
    v_mfma_f32_32x32x16_bf16 v[80:95], v[40:43], v[240:243], v[80:95]
    ds_read_b64_tr_b16 v[52:53], v17 offset:30720
    ds_read_b64_tr_b16 v[54:55], v17 offset:31232
    s_waitcnt lgkmcnt(4)
    v_mfma_f32_32x32x16_bf16 v[80:95], v[44:47], v[244:247], v[80:95]
    s_waitcnt lgkmcnt(2)
    v_mfma_f32_32x32x16_bf16 v[80:95], v[48:51], v[248:251], v[80:95]
    s_waitcnt lgkmcnt(0)
    v_mfma_f32_32x32x16_bf16 v[80:95], v[52:55], v[252:255], v[80:95]
    s_waitcnt vmcnt(0)
    v_mfma_f32_32x32x16_bf16 v[80:95], v[28:31], v[56:59], v[80:95]
    s_nop 11
    v_cvt_pk_bf16_f32 v64, v80, v81
    v_cvt_pk_bf16_f32 v65, v82, v83
    v_cvt_pk_bf16_f32 v66, v84, v85
    v_cvt_pk_bf16_f32 v67, v86, v87
    v_cvt_pk_bf16_f32 v68, v88, v89
    v_cvt_pk_bf16_f32 v69, v90, v91
    v_cvt_pk_bf16_f32 v70, v92, v93
    v_cvt_pk_bf16_f32 v71, v94, v95
    v_mfma_f32_32x32x16_bf16 v[96:111], v[24:27], v[64:67], 0
    s_nop 0
    v_mfma_f32_32x32x16_bf16 v[112:127], v[24:27], v[68:71], 0
    v_mov_b32 v2, 163832
    v_mov_b32 v3, 1
    s_mov_b64 exec, 1
    ds_add_u32 v2, v3
    s_mov_b64 exec, -1
    s_nop 4
    v_max3_f32 v32, v96, v97, v98
    s_nop 0
    v_max3_f32 v36, v120, v121, v122
    v_min3_f32 v33, v96, v97, v98
    v_min3_f32 v37, v120, v121, v122
    v_max3_f32 v32, v32, v99, v100
    v_max3_f32 v36, v36, v123, v124
    v_min3_f32 v33, v33, v99, v100
    v_min3_f32 v37, v37, v123, v124
    v_max3_f32 v32, v32, v101, v102
    v_max3_f32 v36, v36, v125, v126
    v_min3_f32 v33, v33, v101, v102
    v_min3_f32 v37, v37, v125, v126
    v_max_f32 v32, v32, v103
    v_max_f32 v36, v36, v127
    v_max_f32 v33, -v33, -v103
    v_max_f32 v37, -v37, -v127
    s_nop 0
    v_permlane32_swap_b32 v32, v33
    v_permlane32_swap_b32 v36, v37
    v_max_f32 v32, v32, v33
    v_max_f32 v36, v36, v37
    v_mul_f32 v32, v22, v32
    v_mul_f32 v36, v22, v36
    v_mov_b32 v33, v32
    v_mov_b32 v37, v36
    s_nop 0
    v_permlane32_swap_b32 v32, v33
    v_permlane32_swap_b32 v36, v37
    v_fma_f32 v104, v96, v22, -v32
    v_fma_f32 v112, v120, v22, -v36
    v_fma_f32 v96, -v96, v22, -v33
    v_fma_f32 v120, -v120, v22, -v37
    v_fma_f32 v105, v97, v22, -v32
    v_fma_f32 v113, v121, v22, -v36
    v_fma_f32 v97, -v97, v22, -v33
    v_fma_f32 v121, -v121, v22, -v37
    v_fma_f32 v106, v98, v22, -v32
    v_fma_f32 v114, v122, v22, -v36
    v_fma_f32 v98, -v98, v22, -v33
    v_fma_f32 v122, -v122, v22, -v37
    v_fma_f32 v107, v99, v22, -v32
    v_fma_f32 v115, v123, v22, -v36
    v_fma_f32 v99, -v99, v22, -v33
    v_fma_f32 v123, -v123, v22, -v37
    v_fma_f32 v108, v100, v22, -v32
    v_fma_f32 v116, v124, v22, -v36
    v_fma_f32 v100, -v100, v22, -v33
    v_fma_f32 v124, -v124, v22, -v37
    v_fma_f32 v109, v101, v22, -v32
    v_fma_f32 v117, v125, v22, -v36
    v_fma_f32 v101, -v101, v22, -v33
    v_fma_f32 v125, -v125, v22, -v37
    v_fma_f32 v110, v102, v22, -v32
    v_fma_f32 v118, v126, v22, -v36
    v_fma_f32 v102, -v102, v22, -v33
    v_fma_f32 v126, -v126, v22, -v37
    v_fma_f32 v111, v103, v22, -v32
    v_fma_f32 v119, v127, v22, -v36
    v_fma_f32 v103, -v103, v22, -v33
    v_fma_f32 v127, -v127, v22, -v37
    v_exp_f32 v104, v104
    v_exp_f32 v112, v112
    v_exp_f32 v96, v96
    v_exp_f32 v120, v120
    v_exp_f32 v105, v105
    v_exp_f32 v113, v113
    v_exp_f32 v97, v97
    v_exp_f32 v121, v121
    v_exp_f32 v106, v106
    v_exp_f32 v114, v114
    v_exp_f32 v98, v98
    v_exp_f32 v122, v122
    v_exp_f32 v107, v107
    v_exp_f32 v115, v115
    v_exp_f32 v99, v99
    v_exp_f32 v123, v123
    v_exp_f32 v108, v108
    v_exp_f32 v116, v116
    v_exp_f32 v100, v100
    v_exp_f32 v124, v124
    v_exp_f32 v109, v109
    v_exp_f32 v117, v117
    v_exp_f32 v101, v101
    v_exp_f32 v125, v125
    v_exp_f32 v110, v110
    v_exp_f32 v118, v118
    v_exp_f32 v102, v102
    v_exp_f32 v126, v126
    v_exp_f32 v111, v111
    v_exp_f32 v119, v119
    v_exp_f32 v103, v103
    v_exp_f32 v127, v127
    v_add_f32 v34, v104, v105
    v_add_f32 v38, v112, v113
    v_add_f32 v35, v96, v97
    v_add_f32 v39, v120, v121
    v_add_f32 v34, v34, v106
    v_add_f32 v38, v38, v114
    v_add_f32 v35, v35, v98
    v_add_f32 v39, v39, v122
    v_add_f32 v34, v34, v107
    v_add_f32 v38, v38, v115
    v_add_f32 v35, v35, v99
    v_add_f32 v39, v39, v123
    v_add_f32 v34, v34, v108
    v_add_f32 v38, v38, v116
    v_add_f32 v35, v35, v100
    v_add_f32 v39, v39, v124
    v_add_f32 v34, v34, v109
    v_add_f32 v38, v38, v117
    v_add_f32 v35, v35, v101
    v_add_f32 v39, v39, v125
    v_add_f32 v34, v34, v110
    v_add_f32 v38, v38, v118
    v_add_f32 v35, v35, v102
    v_add_f32 v39, v39, v126
    v_add_f32 v34, v34, v111
    v_add_f32 v38, v38, v119
    v_add_f32 v35, v35, v103
    v_add_f32 v39, v39, v127
    s_nop 0
    v_permlane32_swap_b32 v34, v35
    v_permlane32_swap_b32 v38, v39
    v_add_f32 v34, v34, v35
    v_add_f32 v38, v38, v39
    v_rcp_f32 v34, v34
    v_rcp_f32 v38, v38
    v_mov_b32 v35, v34
    v_mov_b32 v39, v38
    s_nop 0
    v_permlane32_swap_b32 v34, v35
    v_permlane32_swap_b32 v38, v39
    v_mul_f32 v104, v104, v34
    v_mul_f32 v112, v112, v38
    v_mul_f32 v96, v96, v35
    v_mul_f32 v120, v120, v39
    v_mul_f32 v105, v105, v34
    v_mul_f32 v113, v113, v38
    v_mul_f32 v97, v97, v35
    v_mul_f32 v121, v121, v39
    v_mul_f32 v106, v106, v34
    v_mul_f32 v114, v114, v38
    v_mul_f32 v98, v98, v35
    v_mul_f32 v122, v122, v39
    v_mul_f32 v107, v107, v34
    v_mul_f32 v115, v115, v38
    v_mul_f32 v99, v99, v35
    v_mul_f32 v123, v123, v39
    v_mul_f32 v108, v108, v34
    v_mul_f32 v116, v116, v38
    v_mul_f32 v100, v100, v35
    v_mul_f32 v124, v124, v39
    v_mul_f32 v109, v109, v34
    v_mul_f32 v117, v117, v38
    v_mul_f32 v101, v101, v35
    v_mul_f32 v125, v125, v39
    v_mul_f32 v110, v110, v34
    v_mul_f32 v118, v118, v38
    v_mul_f32 v102, v102, v35
    v_mul_f32 v126, v126, v39
    v_mul_f32 v111, v111, v34
    v_mul_f32 v119, v119, v38
    v_mul_f32 v103, v103, v35
    v_mul_f32 v127, v127, v39
    v_cvt_pk_bf16_f32 v80, v104, v105
    v_cvt_pk_bf16_f32 v88, v112, v113
    v_cvt_pk_bf16_f32 v81, v106, v107
    v_cvt_pk_bf16_f32 v89, v114, v115
    v_cvt_pk_bf16_f32 v82, v108, v109
    v_cvt_pk_bf16_f32 v90, v116, v117
    v_cvt_pk_bf16_f32 v83, v110, v111
    v_cvt_pk_bf16_f32 v91, v118, v119
    v_cvt_pk_bf16_f32 v84, v96, v97
    v_cvt_pk_bf16_f32 v92, v120, v121
    v_cvt_pk_bf16_f32 v85, v98, v99
    v_cvt_pk_bf16_f32 v93, v122, v123
    v_cvt_pk_bf16_f32 v86, v100, v101
    v_cvt_pk_bf16_f32 v94, v124, v125
    v_cvt_pk_bf16_f32 v87, v102, v103
    v_cvt_pk_bf16_f32 v95, v126, v127
    s_cmp_gt_u32 s48, 3
    s_cbranch_scc1 Lt1_46
    v_lshrrev_b32 v2, 3, v0
    v_and_b32 v3, 7, v0
    v_lshlrev_b32 v56, 10, v2
    v_lshl_add_u32 v56, v3, 4, v56
    s_lshl_b32 s94, s101, 16
    s_lshl_b32 s54, s100, 7
    s_add_u32 s94, s94, s54
    buffer_load_dwordx4 v[36:39], v56, s[4:7], s94 offen
    v_mul_u32_u24 v57, 272, v2
    v_lshl_add_u32 v57, v3, 5, v57
    v_lshlrev_b32 v2, 1, v2
    s_lshl_b32 s54, s101, 7
    buffer_load_ushort v52, v2, s[32:35], s54 offen
    v_mov_b32 v53, 0xbfb8aa3b
    s_lshr_b32 s68, s48, 1
    s_and_b32 s69, s48, 1
    v_bfe_u32 v2, v1, 2, 2
    v_lshrrev_b32 v3, 5, v1
    v_lshl_add_u32 v28, v3, 2, v2
    v_lshlrev_b32 v28, 7, v28
    v_lshrrev_b32 v2, 1, v2
    v_lshl_add_u32 v28, v2, 6, v28
    v_bfe_u32 v2, v1, 4, 1
    v_lshl_add_u32 v28, v2, 5, v28
    v_and_b32 v2, 3, v1
    v_lshl_add_u32 v28, v2, 3, v28
    s_lshl_b32 s54, s68, 12
    v_add_u32 v28, s54, v28
    v_xor_b32 v29, 64, v28
    v_add_u32 v30, 0x10000, v28
    v_add_u32 v31, 0x10000, v29
    v_and_b32 v2, 31, v1
    v_mul_u32_u24 v2, 272, v2
    v_lshl_add_u32 v54, v3, 4, v2
    s_mul_i32 s54, s68, 17408
    v_add_u32 v54, s54, v54
    s_mul_i32 s54, s69, 8704
    v_add_u32 v54, s54, v54
    s_lshl_b32 s54, s69, 6
    v_xor_b32 v32, s54, v28
    v_add_u32 v33, 0x10000, v32
    v_add_u32 v34, 0x20000, v32
    s_lshl_b32 s54, s68, 11
    v_add_u32 v58, s54, v6
    v_add_u32 v59, 0x10000, v58
    s_mov_b32 s96, 0
    s_mov_b64 exec, 0xffff
Lpoll_48:
    buffer_load_dwordx2 v[18:19], v21, s[44:47], 0 offen sc1
    s_waitcnt vmcnt(0)
    v_cmp_ne_u64 vcc, s[52:53], v[18:19]
    s_add_u32 s96, s96, 1
    s_cmp_eq_u64 vcc, 0
    s_cbranch_scc1 Lpd_49
    s_mov_b64 exec, vcc
    s_cmp_gt_u32 s96, 20000
    s_cbranch_scc1 Lpd_49
    s_sleep 1
    s_branch Lpoll_48
Lpd_49:
    s_mov_b64 exec, -1
    v_lshlrev_b32 v2, 4, v0
    s_lshl_b32 s54, s57, 14
    s_add_u32 s54, s54, 8912896
    buffer_load_dwordx4 v[40:43], v2, s[44:47], s54 offen sc1
    s_add_u32 s54, s54, 4096
    buffer_load_dwordx4 v[44:47], v2, s[44:47], s54 offen sc1
    s_add_u32 s54, s54, 4096
    buffer_load_dwordx4 v[48:51], v2, s[44:47], s54 offen sc1
    v_lshrrev_b32 v3, 3, v0
    v_mul_u32_u24 v3, 72, v3
    v_and_b32 v4, 7, v0
    v_lshl_add_u32 v3, v4, 3, v3
    v_add_u32 v3, 155648, v3
    s_waitcnt vmcnt(0)
    v_cvt_pk_bf16_f32 v64, v40, v41
    v_cvt_pk_bf16_f32 v65, v42, v43
    v_cvt_pk_bf16_f32 v66, v44, v45
    v_cvt_pk_bf16_f32 v67, v46, v47
    v_cvt_pk_bf16_f32 v68, v48, v49
    v_cvt_pk_bf16_f32 v69, v50, v51
    ds_write_b64 v3, v[64:65]
    ds_write_b64 v3, v[66:67] offset:2304
    v_cmp_gt_u32 vcc, 32, v0
    s_nop 0
    s_and_saveexec_b64 s[64:65], vcc
    ds_write_b64 v3, v[68:69] offset:4608
    s_mov_b64 exec, -1
    s_branch Lt2_47
Lt1_46:
    v_lshrrev_b32 v2, 3, v0
    v_and_b32 v3, 7, v0
    v_lshlrev_b32 v56, 10, v2
    v_lshl_add_u32 v56, v3, 4, v56
    s_lshl_b32 s94, s101, 16
    s_lshl_b32 s54, s100, 7
    s_add_u32 s94, s94, s54
    buffer_load_dwordx4 v[36:39], v56, s[4:7], s94 offen
    v_mul_u32_u24 v57, 272, v2
    v_lshl_add_u32 v57, v3, 5, v57
    v_lshlrev_b32 v2, 1, v2
    s_lshl_b32 s54, s101, 7
    buffer_load_ushort v52, v2, s[32:35], s54 offen
    v_mov_b32 v53, 0xbfb8aa3b
    v_bfe_u32 v2, v1, 4, 1
    v_lshlrev_b32 v2, 2, v2
    v_and_b32 v3, 7, v1
    v_xor_b32 v2, v2, v3
    v_lshlrev_b32 v2, 4, v2
    v_lshrrev_b32 v3, 3, v1
    s_and_b32 s68, s48, 3
    s_lshl_b32 s68, s68, 1
    s_lshl_b32 s69, s68, 10
    v_lshl_add_u32 v60, v3, 12, v2
    s_lshl_b32 s54, s68, 15
    s_lshl_b32 s55, s101, 7
    s_add_u32 s54, s54, s55
    v_add_u32 v60, s54, v60
    v_lshl_add_u32 v62, v3, 10, v2
    s_lshl_b32 s54, s68, 13
    s_lshl_b32 s55, s100, 7
    s_add_u32 s54, s54, s55
    v_add_u32 v62, s54, v62
    v_add_u32 v61, 0x8000, v60
    v_add_u32 v63, 0x2000, v62
    v_and_b32 v3, 7, v1
    s_lshr_b32 s54, s101, 1
    s_lshl_b32 s54, s54, 3
    v_add_u32 v3, s54, v3
    v_lshlrev_b32 v3, 7, v3
    v_add_u32 v59, 8568832, v3
    v_min_u32 v2, 14, v1
    s_mul_i32 s54, s100, 15
    v_add_u32 v2, s54, v2
    v_lshlrev_b32 v2, 7, v2
    v_add_u32 v58, 8585216, v2
    s_bfe_u32 s55, s48, 0x10001
    s_and_b32 s68, s48, 1
    s_lshl_b32 s68, s68, 11
    s_lshl_b32 s93, s100, 1
    s_add_u32 s93, s93, s55
    s_mul_i32 s93, s93, 92160
    s_add_u32 s93, s93, s68
    s_add_u32 s93, s93, 6291456
    s_and_b32 s68, s48, 1
    s_lshl_b32 s92, s101, 1
    s_add_u32 s92, s92, s68
    s_lshl_b32 s92, s92, 15
    s_lshl_b32 s54, s55, 11
    s_add_u32 s92, s92, s54
    s_add_u32 s92, s92, 4194304
    v_bfe_u32 v2, v1, 2, 2
    v_lshrrev_b32 v3, 5, v1
    v_lshl_add_u32 v28, v3, 2, v2
    v_lshlrev_b32 v28, 7, v28
    v_lshrrev_b32 v2, 1, v2
    v_lshl_add_u32 v28, v2, 6, v28
    v_bfe_u32 v2, v1, 4, 1
    v_lshl_add_u32 v28, v2, 5, v28
    v_and_b32 v2, 3, v1
    v_lshl_add_u32 v28, v2, 3, v28
    s_lshl_b32 s54, s55, 12
    v_add_u32 v28, s54, v28
    v_xor_b32 v29, 64, v28
    v_add_u32 v30, 0x10000, v28
    v_add_u32 v31, 0x10000, v29
    v_and_b32 v2, 31, v1
    v_mul_u32_u24 v2, 272, v2
    v_lshl_add_u32 v54, v3, 4, v2
    s_mul_i32 s54, s55, 17408
    v_add_u32 v54, s54, v54
    s_mul_i32 s54, s68, 8704
    v_add_u32 v54, s54, v54
    s_lshl_b32 s70, s3, 12
    s_add_u32 s70, s70, s93
    s_add_u32 s68, s93, 90112
    s_add_u32 s71, s70, 4096
    s_cmp_ge_u32 s71, s68
    s_cselect_b32 s71, s93, s71
    s_add_u32 s72, s71, 4096
    s_cmp_ge_u32 s72, s68
    s_cselect_b32 s72, s93, s72
    s_add_u32 s73, s72, 4096
    s_cmp_ge_u32 s73, s68
    s_cselect_b32 s73, s93, s73
    s_add_u32 s74, s73, 4096
    s_cmp_ge_u32 s74, s68
    s_cselect_b32 s74, s93, s74
    s_add_u32 s75, s74, 4096
    s_cmp_ge_u32 s75, s68
    s_cselect_b32 s75, s93, s75
    s_add_u32 s76, s75, 4096
    s_cmp_ge_u32 s76, s68
    s_cselect_b32 s76, s93, s76
    s_add_u32 s77, s76, 4096
    s_cmp_ge_u32 s77, s68
    s_cselect_b32 s77, s93, s77
    s_add_u32 s78, s77, 4096
    s_cmp_ge_u32 s78, s68
    s_cselect_b32 s78, s93, s78
    s_add_u32 s79, s78, 4096
    s_cmp_ge_u32 s79, s68
    s_cselect_b32 s79, s93, s79
    s_add_u32 s80, s79, 4096
    s_cmp_ge_u32 s80, s68
    s_cselect_b32 s80, s93, s80
    s_add_u32 s81, s80, 4096
    s_cmp_ge_u32 s81, s68
    s_cselect_b32 s81, s93, s81
    s_add_u32 s82, s81, 4096
    s_cmp_ge_u32 s82, s68
    s_cselect_b32 s82, s93, s82
    s_add_u32 s83, s82, 4096
    s_cmp_ge_u32 s83, s68
    s_cselect_b32 s83, s93, s83
    s_add_u32 s84, s83, 4096
    s_cmp_ge_u32 s84, s68
    s_cselect_b32 s84, s93, s84
    s_add_u32 s85, s84, 4096
    s_cmp_ge_u32 s85, s68
    s_cselect_b32 s85, s93, s85
    s_add_u32 s86, s85, 4096
    s_cmp_ge_u32 s86, s68
    s_cselect_b32 s86, s93, s86
    s_add_u32 s87, s86, 4096
    s_cmp_ge_u32 s87, s68
    s_cselect_b32 s87, s93, s87
    s_add_u32 s88, s87, 4096
    s_cmp_ge_u32 s88, s68
    s_cselect_b32 s88, s93, s88
    s_add_u32 s89, s88, 4096
    s_cmp_ge_u32 s89, s68
    s_cselect_b32 s89, s93, s89
    s_add_u32 s90, s89, 4096
    s_cmp_ge_u32 s90, s68
    s_cselect_b32 s90, s93, s90
    s_add_u32 s91, s90, 4096
    s_cmp_ge_u32 s91, s68
    s_cselect_b32 s91, s93, s91
    v_mov_b32 v2, 163832
    s_mov_b32 s96, 0
Law_50:
    ds_read_b32 v3, v2
    s_waitcnt lgkmcnt(0)
    v_readfirstlane_b32 s95, v3
    s_nop 0
    s_cmp_ge_u32 s95, 8
    s_cbranch_scc1 Lad_51
    s_sleep 1
    s_add_u32 s96, s96, 1
    s_cmp_lt_u32 s96, 1000000
    s_cbranch_scc1 Law_50
Lad_51:
    s_add_u32 s68, s97, 0
    s_and_b32 s68, s68, 7
    s_lshl_b32 s68, s68, 16
    s_add_u32 m0, s69, 32768
    s_nop 0
    buffer_load_dwordx4 v62, s[16:19], s68 offen lds
    s_add_u32 m0, s69, 33792
    s_nop 0
    buffer_load_dwordx4 v63, s[16:19], s68 offen lds
    s_add_u32 s68, s97, 1
    s_and_b32 s68, s68, 7
    s_lshl_b32 s68, s68, 16
    s_add_u32 m0, s69, 40960
    s_nop 0
    buffer_load_dwordx4 v62, s[16:19], s68 offen lds
    s_add_u32 m0, s69, 41984
    s_nop 0
    buffer_load_dwordx4 v63, s[16:19], s68 offen lds
    s_add_u32 s68, s97, 2
    s_and_b32 s68, s68, 7
    s_lshl_b32 s68, s68, 16
    s_add_u32 m0, s69, 49152
    s_nop 0
    buffer_load_dwordx4 v62, s[16:19], s68 offen lds
    s_add_u32 m0, s69, 50176
    s_nop 0
    buffer_load_dwordx4 v63, s[16:19], s68 offen lds
    s_add_u32 s68, s97, 3
    s_and_b32 s68, s68, 7
    s_lshl_b32 s68, s68, 16
    s_add_u32 m0, s69, 57344
    s_nop 0
    buffer_load_dwordx4 v62, s[16:19], s68 offen lds
    s_add_u32 m0, s69, 58368
    s_nop 0
    buffer_load_dwordx4 v63, s[16:19], s68 offen lds
    s_add_u32 s68, s97, 4
    s_and_b32 s68, s68, 7
    s_lshl_b32 s68, s68, 16
    s_add_u32 m0, s69, 65536
    s_nop 0
    buffer_load_dwordx4 v62, s[16:19], s68 offen lds
    s_add_u32 m0, s69, 66560
    s_nop 0
    buffer_load_dwordx4 v63, s[16:19], s68 offen lds
    s_add_u32 s68, s97, 5
    s_and_b32 s68, s68, 7
    s_lshl_b32 s68, s68, 16
    s_add_u32 m0, s69, 73728
    s_nop 0
    buffer_load_dwordx4 v62, s[16:19], s68 offen lds
    s_add_u32 m0, s69, 74752
    s_nop 0
    buffer_load_dwordx4 v63, s[16:19], s68 offen lds
    s_add_u32 s68, s97, 6
    s_and_b32 s68, s68, 7
    s_lshl_b32 s68, s68, 16
    s_add_u32 m0, s69, 81920
    s_nop 0
    buffer_load_dwordx4 v62, s[16:19], s68 offen lds
    s_add_u32 m0, s69, 82944
    s_nop 0
    buffer_load_dwordx4 v63, s[16:19], s68 offen lds
    s_add_u32 s68, s97, 7
    s_and_b32 s68, s68, 7
    s_lshl_b32 s68, s68, 16
    s_add_u32 m0, s69, 90112
    s_nop 0
    buffer_load_dwordx4 v62, s[16:19], s68 offen lds
    s_add_u32 m0, s69, 91136
    s_nop 0
    buffer_load_dwordx4 v63, s[16:19], s68 offen lds
    s_add_u32 s68, s3, 0
    s_cmp_ge_u32 s68, 22
    s_cselect_b32 s54, 22, 0
    s_sub_u32 s68, s68, s54
    s_lshl_b32 s68, s68, 18
    s_add_u32 m0, s69, 98304
    s_nop 0
    buffer_load_dwordx4 v60, s[28:31], s68 offen lds
    s_add_u32 m0, s69, 99328
    s_nop 0
    buffer_load_dwordx4 v61, s[28:31], s68 offen lds
    s_add_u32 s68, s3, 1
    s_cmp_ge_u32 s68, 22
    s_cselect_b32 s54, 22, 0
    s_sub_u32 s68, s68, s54
    s_lshl_b32 s68, s68, 18
    s_add_u32 m0, s69, 106496
    s_nop 0
    buffer_load_dwordx4 v60, s[28:31], s68 offen lds
    s_add_u32 m0, s69, 107520
    s_nop 0
    buffer_load_dwordx4 v61, s[28:31], s68 offen lds
    s_add_u32 s68, s3, 2
    s_cmp_ge_u32 s68, 22
    s_cselect_b32 s54, 22, 0
    s_sub_u32 s68, s68, s54
    s_lshl_b32 s68, s68, 18
    s_add_u32 m0, s69, 114688
    s_nop 0
    buffer_load_dwordx4 v60, s[28:31], s68 offen lds
    s_add_u32 m0, s69, 115712
    s_nop 0
    buffer_load_dwordx4 v61, s[28:31], s68 offen lds
    s_add_u32 s68, s3, 3
    s_cmp_ge_u32 s68, 22
    s_cselect_b32 s54, 22, 0
    s_sub_u32 s68, s68, s54
    s_lshl_b32 s68, s68, 18
    s_add_u32 m0, s69, 122880
    s_nop 0
    buffer_load_dwordx4 v60, s[28:31], s68 offen lds
    s_add_u32 m0, s69, 123904
    s_nop 0
    buffer_load_dwordx4 v61, s[28:31], s68 offen lds
    s_add_u32 s68, s3, 4
    s_cmp_ge_u32 s68, 22
    s_cselect_b32 s54, 22, 0
    s_sub_u32 s68, s68, s54
    s_lshl_b32 s68, s68, 18
    s_add_u32 m0, s69, 16384
    s_nop 0
    buffer_load_dwordx4 v60, s[28:31], s68 offen lds
    s_add_u32 m0, s69, 17408
    s_nop 0
    buffer_load_dwordx4 v61, s[28:31], s68 offen lds
    s_add_u32 s68, s3, 5
    s_cmp_ge_u32 s68, 22
    s_cselect_b32 s54, 22, 0
    s_sub_u32 s68, s68, s54
    s_lshl_b32 s68, s68, 18
    s_add_u32 m0, s69, 24576
    s_nop 0
    buffer_load_dwordx4 v60, s[28:31], s68 offen lds
    s_add_u32 m0, s69, 25600
    s_nop 0
    buffer_load_dwordx4 v61, s[28:31], s68 offen lds
Lt2_47:
    v_and_b32 v2, 31, v1
    v_min_u32 v2, 16, v2
    v_mul_u32_u24 v2, 72, v2
    v_lshrrev_b32 v4, 5, v1
    v_lshl_add_u32 v2, v4, 3, v2
    s_mul_i32 s54, s59, 2448
    s_add_u32 s54, s54, 155648
    v_add_u32 v2, s54, v2
    s_lshl_b32 s54, s56, 2
    s_add_u32 s54, s54, s58
    s_lshl_b32 s54, s54, 15
    s_lshl_b32 s55, s57, 1
    s_add_u32 s55, s55, s59
    s_lshl_b32 s55, s55, 11
    s_add_u32 s54, s54, s55
    s_add_u32 s66, s54, 4194304
    s_waitcnt lgkmcnt(0)
    s_barrier
    ds_read_b64 v[128:129], v2 offset:0
    ds_read_b64 v[130:131], v2 offset:16
    ds_read_b64 v[132:133], v2 offset:32
    ds_read_b64 v[134:135], v2 offset:48
    ds_read_b64 v[136:137], v2 offset:1224
    ds_read_b64 v[138:139], v2 offset:1240
    ds_read_b64 v[140:141], v2 offset:1256
    ds_read_b64 v[142:143], v2 offset:1272
    s_waitcnt lgkmcnt(4)
    v_mfma_f32_32x32x16_bf16 v[160:175], v[128:131], v[80:83], 0
    v_mfma_f32_32x32x16_bf16 v[160:175], v[132:135], v[84:87], v[160:175]
    s_waitcnt lgkmcnt(0)
    v_mfma_f32_32x32x16_bf16 v[176:191], v[136:139], v[88:91], 0
    v_mfma_f32_32x32x16_bf16 v[176:191], v[140:143], v[92:95], v[176:191]
    s_nop 8
    v_add_f32 v168, 0x358637bd, v168
    v_rcp_f32 v168, v168
    s_nop 0
    v_mul_f32 v160, v160, v168
    v_mul_f32 v161, v161, v168
    v_mul_f32 v162, v162, v168
    v_mul_f32 v163, v163, v168
    v_mul_f32 v164, v164, v168
    v_mul_f32 v165, v165, v168
    v_mul_f32 v166, v166, v168
    v_mul_f32 v167, v167, v168
    v_cvt_pk_bf16_f32 v8, v160, v161
    v_cvt_pk_bf16_f32 v9, v162, v163
    v_cvt_pk_bf16_f32 v10, v164, v165
    v_cvt_pk_bf16_f32 v11, v166, v167
    buffer_store_dwordx4 v[8:11], v6, s[44:47], s66 offen offset:0 sc1
    v_add_f32 v184, 0x358637bd, v184
    v_rcp_f32 v184, v184
    s_nop 0
    v_mul_f32 v176, v176, v184
    v_mul_f32 v177, v177, v184
    v_mul_f32 v178, v178, v184
    v_mul_f32 v179, v179, v184
    v_mul_f32 v180, v180, v184
    v_mul_f32 v181, v181, v184
    v_mul_f32 v182, v182, v184
    v_mul_f32 v183, v183, v184
    v_cvt_pk_bf16_f32 v12, v176, v177
    v_cvt_pk_bf16_f32 v13, v178, v179
    v_cvt_pk_bf16_f32 v14, v180, v181
    v_cvt_pk_bf16_f32 v15, v182, v183
    buffer_store_dwordx4 v[12:15], v6, s[44:47], s66 offen offset:1024 sc1
    s_waitcnt vmcnt(0)
    s_barrier
    s_cmp_lg_u32 s48, 0
    s_cbranch_scc1 Lw0_52
    v_mov_b32 v2, s52
    v_mov_b32 v3, s53
    v_mov_b32 v4, 0
    s_mov_b64 exec, 1
    buffer_store_dwordx2 v[2:3], v4, s[44:47], s61 offen sc1
    s_mov_b64 exec, -1
Lw0_52:
    s_cmp_lt_u32 s48, 4
    s_cbranch_scc1 L_pcons
    s_branch L_pload
L_end:
    s_endpgm
.section .rodata,"a"
.p2align 6
.amdhsa_kernel recurrent_scan__linear_kernel_hedgehog__mixer_token_mlp__prompt_kernel
  .amdhsa_next_free_vgpr 256
  .amdhsa_next_free_sgpr 102
  .amdhsa_accum_offset 256
  .amdhsa_group_segment_fixed_size 0
  .amdhsa_kernarg_size 96
  .amdhsa_user_sgpr_count 2
  .amdhsa_user_sgpr_kernarg_segment_ptr 1
  .amdhsa_system_sgpr_workgroup_id_x 1
  .amdhsa_float_denorm_mode_32 3
.end_amdhsa_kernel
```
